```python
import torch

def _softmax(x, axis=-1):
    return torch.softmax(x, dim=axis)
def _gelu(x):
    return torch.nn.functional.gelu(x, approximate="tanh")
def _silu(x):
    return torch.nn.functional.silu(x)
def _sigmoid(x):
    return torch.sigmoid(x)
def _layernorm(x, axis=-1, eps=1e-5):
    m = x.mean(dim=axis, keepdim=True)
    v = x.var(dim=axis, keepdim=True, unbiased=False)
    return (x - m) / torch.sqrt(v + eps)
def _scatter_add(tgt, idx, src, axis=0):
    return tgt.clone().index_add_(axis, idx, src)
def _segment_sum(src, seg, n):
    out = torch.zeros((n,) + src.shape[1:], dtype=src.dtype)
    return out.index_add_(0, seg, src)
def _pad(x, pw):
    flat = tuple(v for pair in reversed(pw) for v in pair)
    return torch.nn.functional.pad(x, flat)

kernel_name = 'gated_mix__mha_block__moe_arch_mod__prompt'

def setup_inputs():

    _w = (lambda a: (lambda t: t.to(torch.bfloat16) if t.is_floating_point() else t)(torch.as_tensor(a)))
    def _A_setup():
        B, S, D, H = 1, 2048, 512, 32
        return {
            "x": _w((lambda *s: torch.randn(*s, dtype=torch.bfloat16) * 0.05)(B, S, D)),
            "wqkv": _w((lambda *s: torch.randn(*s, dtype=torch.bfloat16) * 0.8)(D, 3 * D)),
            "wo": _w((lambda *s: torch.randn(*s, dtype=torch.bfloat16) * 0.1)(D, D)),
        }
    _A_in = _A_setup()

    def _B_setup():
        B, S, D, F, C = 1, 2048, 512, 1792, 1
        return {
            "x": _w((lambda *s: torch.randn(*s, dtype=torch.bfloat16) * 0.05)(B, S, D)),
            "w_r": _w((lambda *s: torch.randn(*s, dtype=torch.bfloat16) * 1.6)(D)),
            "w_gate": _w((lambda *s: torch.randn(*s, dtype=torch.bfloat16) * 0.2)(D, F)),
            "w_up": _w((lambda *s: torch.randn(*s, dtype=torch.bfloat16) * 0.2)(D, F)),
            "w_down": _w((lambda *s: torch.randn(*s, dtype=torch.bfloat16) * 0.2)(F, D)),
        }
    _B_in = _B_setup()

    return {
        "A_x": _A_in["x"],
        "A_wqkv": _A_in["wqkv"],
        "A_wo": _A_in["wo"],
        "B_x": _B_in["x"],
        "B_w_r": _B_in["w_r"],
        "B_w_gate": _B_in["w_gate"],
        "B_w_up": _B_in["w_up"],
        "B_w_down": _B_in["w_down"],
        "gate_w": _w((lambda *s: torch.randn(*s, dtype=torch.bfloat16) * 0.05)(512) * 16.0),
    }

def reference(A_x, A_wqkv, A_wo, B_x, B_w_r, B_w_gate, B_w_up, B_w_down, gate_w):
    def _A_ref(x, wqkv, wo):
        B, S, D = x.shape
        H = 32
        Dh = D // H
        qkv = (lambda x, *d: x.permute(*d))((x @ wqkv).reshape(B, S, 3, H, Dh), 2, 0, 3, 1, 4)
        q, k, v = qkv[0], qkv[1], qkv[2]
        scores = torch.einsum("bhqd,bhkd->bhqk", q, k) * (Dh ** -0.5)
        p = _softmax(scores, axis=-1)
        o = torch.einsum("bhqk,bhkd->bhqd", p, v)
        return (lambda x, *d: x.permute(*d))(o, 0, 2, 1, 3).reshape(B, S, D) @ wo

    def _B_ref(x, w_r, w_gate, w_up, w_down):
        B, S, D = x.shape
        C = 1
        r = x @ w_r
        idx = torch.argsort(-r, axis=-1)[:, :C]
        idx_e = (lambda x, n, axis: torch.repeat_interleave(x, n, dim=axis))(idx.reshape(B, C, 1), D, axis=2)
        x_sel = (lambda x, i, axis: torch.take_along_dim(x, i, dim=axis))(x, idx_e, axis=1)
        g = _silu(x_sel @ w_gate)
        u = x_sel @ w_up
        y = (g * u) @ w_down
        r_sel = _sigmoid((lambda x, i, axis: torch.take_along_dim(x, i, dim=axis))(r, idx, axis=1))
        y = y * r_sel.reshape(B, C, 1)
        b_off = (torch.arange(B) * S).reshape(B, 1)
        flat_idx = (idx + b_off).reshape(B * C)
        zero = (x * 0.0).reshape(B * S, D)
        upd = _scatter_add(zero, flat_idx, y.reshape(B * C, D), axis=0)
        return x + upd.reshape(B, S, D)

    x = A_x
    g = _sigmoid((x * gate_w).sum(-1, keepdims=True))
    a = _A_ref(x, A_wqkv, A_wo)
    b = _B_ref(x, B_w_r, B_w_gate, B_w_up, B_w_down)
    return g * a + (1 - g) * b
```

```asm
; @launch grid=(256,1,1) block=(512,1,1) lds=162816
.amdgcn_target "amdgcn-amd-amdhsa--gfx950"
.text
.globl gated_mix__mha_block__moe_arch_mod__prompt_kernel
.p2align 8
.type gated_mix__mha_block__moe_arch_mod__prompt_kernel,@function
gated_mix__mha_block__moe_arch_mod__prompt_kernel:
    s_cmp_ge_u32 s2, 256
    s_cbranch_scc1 L_END
    s_load_dwordx16 s[64:79], s[0:1], 0
    s_load_dwordx8 s[80:87], s[0:1], 64
    s_getpc_b64 s[22:23]
L_PC:
    v_subrev_u32 v2, 256, v0
    v_lshlrev_b32 v2, 7, v2
    v_cmp_gt_u32 vcc, L_CODE_END - L_PC, v2
    s_and_saveexec_b64 s[24:25], vcc
    s_cbranch_execz L_NOPF
    global_load_dword v3, v2, s[22:23]
L_NOPF:
    s_mov_b64 exec, -1
    v_lshrrev_b32 v1, 6, v0
    v_and_b32 v0, 63, v0
    v_readfirstlane_b32 s19, v1
    s_and_b32 s16, s2, 7
    s_lshr_b32 s17, s2, 3
    s_and_b32 s14, s16, 0
    s_lshl_b32 s14, s14, 5
    s_and_b32 s18, s17, 31
    s_add_u32 s14, s14, s18
    s_lshr_b32 s15, s16, 0
    s_mul_i32 s15, s15, 1
    s_lshr_b32 s17, s17, 5
    s_add_u32 s15, s15, s17
    s_mul_i32 s17, s15, 1
    s_add_u32 s16, s17, s18
    s_and_b32 s16, s16, 7
    s_and_b32 s62, s2, 7
    s_lshl_b32 s62, s62, 2
    s_bfe_u32 s38, s2, 0x20003
    s_add_u32 s62, s62, s38
    s_lshr_b32 s63, s2, 5
    s_lshl_b32 s38, s38, 1
    s_add_u32 s38, s38, s63
    s_and_b32 s38, s38, 7
    v_lshlrev_b32 v2, 4, v0
    v_and_b32 v6, 31, v0
    v_lshrrev_b32 v7, 5, v0
    v_mov_b32 v254, 151552
    s_and_b32 s20, s19, 1
    v_bfe_u32 v24, v6, 1, 3
    v_lshlrev_b32 v25, 7, v6
    s_lshl_b32 s18, s20, 12
    v_add_u32 v25, s18, v25
    v_or_b32 v26, 0, v7
    v_xor_b32 v26, v26, v24
    v_lshl_add_u32 v8, v26, 4, v25
    v_or_b32 v26, 2, v7
    v_xor_b32 v26, v26, v24
    v_lshl_add_u32 v9, v26, 4, v25
    v_or_b32 v26, 4, v7
    v_xor_b32 v26, v26, v24
    v_lshl_add_u32 v10, v26, 4, v25
    v_or_b32 v26, 6, v7
    v_xor_b32 v26, v26, v24
    v_lshl_add_u32 v11, v26, 4, v25
    s_lshl_b32 s47, s14, 1
    s_add_u32 s39, s47, s20
    s_cmp_ge_u32 s19, 4
    s_cbranch_scc1 P1_COMPUTE
    v_lshrrev_b32 v4, 3, v0
    v_lshlrev_b32 v5, 10, v4
    v_and_b32 v3, 7, v0
    v_lshrrev_b32 v16, 4, v0
    v_xor_b32 v17, v3, v16
    v_lshl_add_u32 v5, v17, 4, v5
    v_mul_u32_u24 v4, 3072, v4
    v_and_b32 v16, 1, v16
    v_lshlrev_b32 v16, 2, v16
    v_xor_b32 v17, v3, v16
    v_lshl_add_u32 v4, v17, 4, v4
    s_lshl_b32 s18, s15, 7
    v_add_u32 v4, s18, v4
    v_xor_b32 v3, 64, v5
    s_lshl_b32 s40, s14, 16
    s_lshl_b32 s18, s19, 14
    s_add_u32 s40, s40, s18
    s_lshl_b32 s44, s19, 11
    s_lshl_b32 s18, s16, 7
    v_add_u32 v16, s18, v2
    v_and_b32 v16, 1023, v16
    s_mul_i32 s41, s19, 49152
    s_lshl_b32 s45, s19, 12
    s_mul_i32 s42, s20, 98304
    s_lshr_b32 s43, s19, 1
    s_waitcnt lgkmcnt(0)
    s_mov_b32 s20, s64
    s_and_b32 s21, s65, 0xffff
    s_mov_b32 s22, 0x200000
    s_mov_b32 s23, 0x00020000
    s_mov_b32 s24, s66
    s_and_b32 s25, s67, 0xffff
    s_mov_b32 s26, 0x180000
    s_mov_b32 s27, 0x00020000
    s_mov_b32 s88, s86
    s_and_b32 s89, s87, 0xffff
    s_mov_b32 s90, 0x800000
    s_mov_b32 s91, 0x00020000
    s_mov_b32 s51, s16
    s_lshl_b32 s46, s51, 7
    s_add_u32 s46, s46, s40
    s_add_u32 m0, s44, 0
    s_add_u32 s48, s46, 8192
    buffer_load_dwordx4 v5, s[20:23], s46 offen lds
    s_add_u32 m0, s44, 1024
    s_add_u32 s51, s51, 1
    buffer_load_dwordx4 v3, s[20:23], s48 offen lds
    s_and_b32 s51, s51, 7
    s_mul_i32 s47, s16, 196608
    s_add_u32 s47, s47, s41
    s_add_u32 s49, s47, 24576
    s_add_u32 m0, s45, 64512
    s_add_u32 s16, s16, 1
    buffer_load_dwordx4 v4, s[24:27], s47 offen offset:1024 lds
    buffer_load_dwordx4 v4, s[24:27], s47 offen offset:2048 lds
    s_add_u32 m0, s45, 66560
    s_and_b32 s16, s16, 7
    buffer_load_dwordx4 v4, s[24:27], s49 offen offset:1024 lds
    buffer_load_dwordx4 v4, s[24:27], s49 offen offset:2048 lds
    s_mov_b32 s28, s72
    s_and_b32 s29, s73, 0xffff
    s_mov_b32 s30, 0x400
    s_mov_b32 s31, 0x00020000
    s_mov_b32 s32, s80
    s_and_b32 s33, s81, 0xffff
    s_mov_b32 s34, 0x400
    s_mov_b32 s35, 0x00020000
    s_mov_b32 m0, 149504
    s_nop 0
    buffer_load_dwordx4 v16, s[32:35], 0 offen lds
    s_mov_b32 m0, 150528
    s_nop 0
    buffer_load_dwordx4 v16, s[28:31], 0 offen lds
    s_lshl_b32 s46, s51, 7
    s_add_u32 s46, s46, s40
    s_add_u32 m0, s44, 8192
    s_add_u32 s48, s46, 8192
    buffer_load_dwordx4 v5, s[20:23], s46 offen lds
    s_add_u32 m0, s44, 9216
    s_add_u32 s51, s51, 1
    buffer_load_dwordx4 v3, s[20:23], s48 offen lds
    s_and_b32 s51, s51, 7
    s_mul_i32 s47, s16, 196608
    s_add_u32 s47, s47, s41
    s_add_u32 s49, s47, 24576
    s_add_u32 m0, s45, 80896
    s_add_u32 s16, s16, 1
    buffer_load_dwordx4 v4, s[24:27], s47 offen offset:1024 lds
    buffer_load_dwordx4 v4, s[24:27], s47 offen offset:2048 lds
    s_add_u32 m0, s45, 82944
    s_and_b32 s16, s16, 7
    buffer_load_dwordx4 v4, s[24:27], s49 offen offset:1024 lds
    buffer_load_dwordx4 v4, s[24:27], s49 offen offset:2048 lds
    s_lshl_b32 s46, s51, 7
    s_add_u32 s46, s46, s40
    s_add_u32 m0, s44, 16384
    s_add_u32 s48, s46, 8192
    buffer_load_dwordx4 v5, s[20:23], s46 offen lds
    s_add_u32 m0, s44, 17408
    s_add_u32 s51, s51, 1
    buffer_load_dwordx4 v3, s[20:23], s48 offen lds
    s_and_b32 s51, s51, 7
    s_mul_i32 s47, s16, 196608
    s_add_u32 s47, s47, s41
    s_add_u32 s49, s47, 24576
    s_add_u32 m0, s45, 97280
    s_add_u32 s16, s16, 1
    buffer_load_dwordx4 v4, s[24:27], s47 offen offset:1024 lds
    buffer_load_dwordx4 v4, s[24:27], s47 offen offset:2048 lds
    s_add_u32 m0, s45, 99328
    s_and_b32 s16, s16, 7
    buffer_load_dwordx4 v4, s[24:27], s49 offen offset:1024 lds
    buffer_load_dwordx4 v4, s[24:27], s49 offen offset:2048 lds
    s_and_b32 s50, s14, 7
    s_xor_b32 s50, s50, s15
    s_lshr_b32 s57, s19, 1
    s_or_b32 s50, s50, s57
    v_and_b32 v25, 1, v0
    v_lshlrev_b32 v25, 10, v25
    v_lshl_add_u32 v17, v7, 4, v25
    v_add_u32 v17, 149504, v17
    v_mov_b64 v[32:33], 0
    v_mov_b64 v[34:35], 0
    v_mov_b64 v[36:37], 0
    v_mov_b64 v[38:39], 0
    v_mov_b64 v[40:41], 0
    v_mov_b64 v[42:43], 0
    v_mov_b64 v[44:45], 0
    v_mov_b64 v[46:47], 0
    ds_write_b128 v254, v[32:35]
    ds_write_b128 v254, v[32:35] offset:16
    ds_write_b128 v254, v[32:35] offset:32
    ds_write_b128 v254, v[32:35] offset:48
    ds_write_b128 v254, v[32:35] offset:64
    s_waitcnt vmcnt(14) lgkmcnt(0)
    s_barrier
    s_lshl_b32 s46, s51, 7
    s_add_u32 s46, s46, s40
    s_add_u32 m0, s44, 24576
    s_add_u32 s48, s46, 8192
    buffer_load_dwordx4 v5, s[20:23], s46 offen lds
    s_add_u32 m0, s44, 25600
    s_add_u32 s51, s51, 1
    buffer_load_dwordx4 v3, s[20:23], s48 offen lds
    s_and_b32 s51, s51, 7
    s_mul_i32 s47, s16, 196608
    s_add_u32 s47, s47, s41
    s_add_u32 s49, s47, 24576
    s_add_u32 m0, s45, 113664
    s_add_u32 s16, s16, 1
    buffer_load_dwordx4 v4, s[24:27], s47 offen offset:1024 lds
    buffer_load_dwordx4 v4, s[24:27], s47 offen offset:2048 lds
    s_add_u32 m0, s45, 115712
    s_and_b32 s16, s16, 7
    buffer_load_dwordx4 v4, s[24:27], s49 offen offset:1024 lds
    buffer_load_dwordx4 v4, s[24:27], s49 offen offset:2048 lds
    s_mov_b32 s32, s84
    s_and_b32 s33, s85, 0xffff
    s_mov_b32 s34, 0x100
    s_mov_b32 s35, 0x00020000
    s_waitcnt vmcnt(12)
    s_barrier
    s_lshl_b32 s46, s51, 7
    s_add_u32 s46, s46, s40
    s_add_u32 m0, s44, 32768
    s_add_u32 s48, s46, 8192
    buffer_load_dwordx4 v5, s[20:23], s46 offen lds
    s_add_u32 m0, s44, 33792
    s_add_u32 s51, s51, 1
    buffer_load_dwordx4 v3, s[20:23], s48 offen lds
    s_and_b32 s51, s51, 7
    s_mul_i32 s47, s16, 196608
    s_add_u32 s47, s47, s41
    s_add_u32 s49, s47, 24576
    s_add_u32 m0, s45, 64512
    s_add_u32 s16, s16, 1
    buffer_load_dwordx4 v4, s[24:27], s47 offen offset:1024 lds
    buffer_load_dwordx4 v4, s[24:27], s47 offen offset:2048 lds
    s_add_u32 m0, s45, 66560
    s_and_b32 s16, s16, 7
    buffer_load_dwordx4 v4, s[24:27], s49 offen offset:1024 lds
    buffer_load_dwordx4 v4, s[24:27], s49 offen offset:2048 lds
    s_waitcnt vmcnt(12)
    s_barrier
    s_lshl_b32 s46, s51, 7
    s_add_u32 s46, s46, s40
    s_add_u32 m0, s44, 40960
    s_add_u32 s48, s46, 8192
    buffer_load_dwordx4 v5, s[20:23], s46 offen lds
    s_add_u32 m0, s44, 41984
    s_add_u32 s51, s51, 1
    buffer_load_dwordx4 v3, s[20:23], s48 offen lds
    s_and_b32 s51, s51, 7
    s_mul_i32 s47, s16, 196608
    s_add_u32 s47, s47, s41
    s_add_u32 s49, s47, 24576
    s_add_u32 m0, s45, 80896
    s_add_u32 s16, s16, 1
    buffer_load_dwordx4 v4, s[24:27], s47 offen offset:1024 lds
    buffer_load_dwordx4 v4, s[24:27], s47 offen offset:2048 lds
    s_add_u32 m0, s45, 82944
    s_and_b32 s16, s16, 7
    buffer_load_dwordx4 v4, s[24:27], s49 offen offset:1024 lds
    buffer_load_dwordx4 v4, s[24:27], s49 offen offset:2048 lds
    s_waitcnt vmcnt(12)
    s_barrier
    s_lshl_b32 s46, s51, 7
    s_add_u32 s46, s46, s40
    s_add_u32 m0, s44, 49152
    s_add_u32 s48, s46, 8192
    buffer_load_dwordx4 v5, s[20:23], s46 offen lds
    s_add_u32 m0, s44, 50176
    s_add_u32 s51, s51, 1
    buffer_load_dwordx4 v3, s[20:23], s48 offen lds
    s_and_b32 s51, s51, 7
    s_mul_i32 s47, s16, 196608
    s_add_u32 s47, s47, s41
    s_add_u32 s49, s47, 24576
    s_add_u32 m0, s45, 97280
    s_add_u32 s16, s16, 1
    buffer_load_dwordx4 v4, s[24:27], s47 offen offset:1024 lds
    buffer_load_dwordx4 v4, s[24:27], s47 offen offset:2048 lds
    s_add_u32 m0, s45, 99328
    s_and_b32 s16, s16, 7
    buffer_load_dwordx4 v4, s[24:27], s49 offen offset:1024 lds
    buffer_load_dwordx4 v4, s[24:27], s49 offen offset:2048 lds
    s_waitcnt vmcnt(12)
    s_barrier
    s_lshl_b32 s46, s51, 7
    s_add_u32 s46, s46, s40
    s_add_u32 m0, s44, 57344
    s_add_u32 s48, s46, 8192
    buffer_load_dwordx4 v5, s[20:23], s46 offen lds
    s_add_u32 m0, s44, 58368
    s_add_u32 s51, s51, 1
    buffer_load_dwordx4 v3, s[20:23], s48 offen lds
    s_and_b32 s51, s51, 7
    s_mul_i32 s47, s16, 196608
    s_add_u32 s47, s47, s41
    s_add_u32 s49, s47, 24576
    s_add_u32 m0, s45, 113664
    s_add_u32 s16, s16, 1
    buffer_load_dwordx4 v4, s[24:27], s47 offen offset:1024 lds
    buffer_load_dwordx4 v4, s[24:27], s47 offen offset:2048 lds
    s_add_u32 m0, s45, 115712
    s_and_b32 s16, s16, 7
    buffer_load_dwordx4 v4, s[24:27], s49 offen offset:1024 lds
    buffer_load_dwordx4 v4, s[24:27], s49 offen offset:2048 lds
    s_waitcnt vmcnt(12)
    s_barrier
    s_add_u32 s46, s16, s43
    s_and_b32 s46, s46, 7
    s_mul_i32 s47, s46, 196608
    s_add_u32 s47, s47, s42
    s_add_u32 s16, s16, 2
    s_add_u32 m0, s45, 65536
    s_add_u32 s48, s47, 0
    buffer_load_dwordx4 v4, s[24:27], s48 offen lds
    s_add_u32 m0, s45, 66560
    s_add_u32 s48, s47, 24576
    buffer_load_dwordx4 v4, s[24:27], s48 offen lds
    s_add_u32 m0, s45, 67584
    s_add_u32 s48, s47, 49152
    buffer_load_dwordx4 v4, s[24:27], s48 offen lds
    s_add_u32 m0, s45, 68608
    s_add_u32 s48, s47, 73728
    buffer_load_dwordx4 v4, s[24:27], s48 offen lds
    s_waitcnt vmcnt(10)
    s_barrier
    s_add_u32 s46, s16, s43
    s_and_b32 s46, s46, 7
    s_mul_i32 s47, s46, 196608
    s_add_u32 s47, s47, s42
    s_add_u32 s16, s16, 2
    s_add_u32 m0, s45, 81920
    s_add_u32 s48, s47, 0
    buffer_load_dwordx4 v4, s[24:27], s48 offen lds
    s_add_u32 m0, s45, 82944
    s_add_u32 s48, s47, 24576
    buffer_load_dwordx4 v4, s[24:27], s48 offen lds
    s_add_u32 m0, s45, 83968
    s_add_u32 s48, s47, 49152
    buffer_load_dwordx4 v4, s[24:27], s48 offen lds
    s_add_u32 m0, s45, 84992
    s_add_u32 s48, s47, 73728
    buffer_load_dwordx4 v4, s[24:27], s48 offen lds
    s_waitcnt vmcnt(8)
    s_barrier
    s_add_u32 s46, s16, s43
    s_and_b32 s46, s46, 7
    s_mul_i32 s47, s46, 196608
    s_add_u32 s47, s47, s42
    s_add_u32 s16, s16, 2
    s_add_u32 m0, s45, 98304
    s_add_u32 s48, s47, 0
    buffer_load_dwordx4 v4, s[24:27], s48 offen lds
    s_add_u32 m0, s45, 99328
    s_add_u32 s48, s47, 24576
    buffer_load_dwordx4 v4, s[24:27], s48 offen lds
    s_add_u32 m0, s45, 100352
    s_add_u32 s48, s47, 49152
    buffer_load_dwordx4 v4, s[24:27], s48 offen lds
    s_add_u32 m0, s45, 101376
    s_add_u32 s48, s47, 73728
    buffer_load_dwordx4 v4, s[24:27], s48 offen lds
    s_waitcnt vmcnt(8)
    s_barrier
    s_add_u32 s46, s16, s43
    s_and_b32 s46, s46, 7
    s_mul_i32 s47, s46, 196608
    s_add_u32 s47, s47, s42
    s_add_u32 s16, s16, 2
    s_add_u32 m0, s45, 114688
    s_add_u32 s48, s47, 0
    buffer_load_dwordx4 v4, s[24:27], s48 offen lds
    s_add_u32 m0, s45, 115712
    s_add_u32 s48, s47, 24576
    buffer_load_dwordx4 v4, s[24:27], s48 offen lds
    s_add_u32 m0, s45, 116736
    s_add_u32 s48, s47, 49152
    buffer_load_dwordx4 v4, s[24:27], s48 offen lds
    s_add_u32 m0, s45, 117760
    s_add_u32 s48, s47, 73728
    buffer_load_dwordx4 v4, s[24:27], s48 offen lds
    s_cmp_lg_u32 s50, 0
    s_cbranch_scc1 P1_NR8
    ds_read_b128 v[48:51], v8 offset:0
    ds_read_b128 v[52:55], v17 offset:0
    ds_read_b128 v[56:59], v9 offset:0
    ds_read_b128 v[60:63], v17 offset:32
    ds_read_b128 v[64:67], v10 offset:0
    ds_read_b128 v[68:71], v17 offset:64
    ds_read_b128 v[72:75], v11 offset:0
    ds_read_b128 v[76:79], v17 offset:96
    ds_read_b128 v[80:83], v8 offset:8192
    ds_read_b128 v[84:87], v17 offset:128
    s_waitcnt lgkmcnt(8)
    v_mfma_f32_32x32x16_bf16 v[32:47], v[52:55], v[48:51], v[32:47]
    ds_read_b128 v[88:91], v9 offset:8192
    ds_read_b128 v[92:95], v17 offset:160
    s_waitcnt lgkmcnt(8)
    v_mfma_f32_32x32x16_bf16 v[32:47], v[60:63], v[56:59], v[32:47]
    ds_read_b128 v[48:51], v10 offset:8192
    ds_read_b128 v[52:55], v17 offset:192
    s_waitcnt lgkmcnt(8)
    v_mfma_f32_32x32x16_bf16 v[32:47], v[68:71], v[64:67], v[32:47]
    ds_read_b128 v[56:59], v11 offset:8192
    ds_read_b128 v[60:63], v17 offset:224
    s_waitcnt lgkmcnt(8)
    v_mfma_f32_32x32x16_bf16 v[32:47], v[76:79], v[72:75], v[32:47]
    ds_read_b128 v[64:67], v8 offset:16384
    ds_read_b128 v[68:71], v17 offset:256
    s_waitcnt lgkmcnt(8)
    v_mfma_f32_32x32x16_bf16 v[32:47], v[84:87], v[80:83], v[32:47]
    ds_read_b128 v[72:75], v9 offset:16384
    ds_read_b128 v[76:79], v17 offset:288
    s_waitcnt lgkmcnt(8)
    v_mfma_f32_32x32x16_bf16 v[32:47], v[92:95], v[88:91], v[32:47]
    ds_read_b128 v[80:83], v10 offset:16384
    ds_read_b128 v[84:87], v17 offset:320
    s_waitcnt lgkmcnt(8)
    v_mfma_f32_32x32x16_bf16 v[32:47], v[52:55], v[48:51], v[32:47]
    ds_read_b128 v[88:91], v11 offset:16384
    ds_read_b128 v[92:95], v17 offset:352
    s_waitcnt lgkmcnt(8)
    v_mfma_f32_32x32x16_bf16 v[32:47], v[60:63], v[56:59], v[32:47]
    ds_read_b128 v[48:51], v8 offset:24576
    ds_read_b128 v[52:55], v17 offset:384
    s_waitcnt lgkmcnt(8)
    v_mfma_f32_32x32x16_bf16 v[32:47], v[68:71], v[64:67], v[32:47]
    ds_read_b128 v[56:59], v9 offset:24576
    ds_read_b128 v[60:63], v17 offset:416
    s_waitcnt lgkmcnt(8)
    v_mfma_f32_32x32x16_bf16 v[32:47], v[76:79], v[72:75], v[32:47]
    ds_read_b128 v[64:67], v10 offset:24576
    ds_read_b128 v[68:71], v17 offset:448
    s_waitcnt lgkmcnt(8)
    v_mfma_f32_32x32x16_bf16 v[32:47], v[84:87], v[80:83], v[32:47]
    ds_read_b128 v[72:75], v11 offset:24576
    ds_read_b128 v[76:79], v17 offset:480
P1_NR8:
    s_waitcnt vmcnt(8)
    s_barrier
    buffer_load_dwordx2 v[28:29], off, s[32:35], 0 sc1
    s_cmp_lg_u32 s50, 0
    s_cbranch_scc1 P1_NR9
    s_waitcnt lgkmcnt(8)
    v_mfma_f32_32x32x16_bf16 v[32:47], v[92:95], v[88:91], v[32:47]
    ds_read_b128 v[80:83], v8 offset:32768
    ds_read_b128 v[84:87], v17 offset:512
    s_waitcnt lgkmcnt(8)
    v_mfma_f32_32x32x16_bf16 v[32:47], v[52:55], v[48:51], v[32:47]
    ds_read_b128 v[88:91], v9 offset:32768
    ds_read_b128 v[92:95], v17 offset:544
    s_waitcnt lgkmcnt(8)
    v_mfma_f32_32x32x16_bf16 v[32:47], v[60:63], v[56:59], v[32:47]
    ds_read_b128 v[48:51], v10 offset:32768
    ds_read_b128 v[52:55], v17 offset:576
    s_waitcnt lgkmcnt(8)
    v_mfma_f32_32x32x16_bf16 v[32:47], v[68:71], v[64:67], v[32:47]
    ds_read_b128 v[56:59], v11 offset:32768
    ds_read_b128 v[60:63], v17 offset:608
    s_waitcnt lgkmcnt(8)
    v_mfma_f32_32x32x16_bf16 v[32:47], v[76:79], v[72:75], v[32:47]
    ds_read_b128 v[64:67], v8 offset:40960
    ds_read_b128 v[68:71], v17 offset:640
    s_waitcnt lgkmcnt(8)
    v_mfma_f32_32x32x16_bf16 v[32:47], v[84:87], v[80:83], v[32:47]
    ds_read_b128 v[72:75], v9 offset:40960
    ds_read_b128 v[76:79], v17 offset:672
    s_waitcnt lgkmcnt(8)
    v_mfma_f32_32x32x16_bf16 v[32:47], v[92:95], v[88:91], v[32:47]
    ds_read_b128 v[80:83], v10 offset:40960
    ds_read_b128 v[84:87], v17 offset:704
    s_waitcnt lgkmcnt(8)
    v_mfma_f32_32x32x16_bf16 v[32:47], v[52:55], v[48:51], v[32:47]
    ds_read_b128 v[88:91], v11 offset:40960
    ds_read_b128 v[92:95], v17 offset:736
    s_waitcnt lgkmcnt(8)
    v_mfma_f32_32x32x16_bf16 v[32:47], v[60:63], v[56:59], v[32:47]
    ds_read_b128 v[48:51], v8 offset:49152
    ds_read_b128 v[52:55], v17 offset:768
    s_waitcnt lgkmcnt(8)
    v_mfma_f32_32x32x16_bf16 v[32:47], v[68:71], v[64:67], v[32:47]
    ds_read_b128 v[56:59], v9 offset:49152
    ds_read_b128 v[60:63], v17 offset:800
    s_waitcnt lgkmcnt(8)
    v_mfma_f32_32x32x16_bf16 v[32:47], v[76:79], v[72:75], v[32:47]
    ds_read_b128 v[64:67], v10 offset:49152
    ds_read_b128 v[68:71], v17 offset:832
P1_NR9:
    s_waitcnt vmcnt(5)
    s_barrier
    s_cmp_lg_u32 s50, 0
    s_cbranch_scc1 P1_NR10
    s_waitcnt lgkmcnt(8)
    v_mfma_f32_32x32x16_bf16 v[32:47], v[84:87], v[80:83], v[32:47]
    ds_read_b128 v[72:75], v11 offset:49152
    ds_read_b128 v[76:79], v17 offset:864
    s_waitcnt lgkmcnt(8)
    v_mfma_f32_32x32x16_bf16 v[32:47], v[92:95], v[88:91], v[32:47]
    ds_read_b128 v[80:83], v8 offset:57344
    ds_read_b128 v[84:87], v17 offset:896
    s_waitcnt lgkmcnt(8)
    v_mfma_f32_32x32x16_bf16 v[32:47], v[52:55], v[48:51], v[32:47]
    ds_read_b128 v[88:91], v9 offset:57344
    ds_read_b128 v[92:95], v17 offset:928
    s_waitcnt lgkmcnt(8)
    v_mfma_f32_32x32x16_bf16 v[32:47], v[60:63], v[56:59], v[32:47]
    ds_read_b128 v[48:51], v10 offset:57344
    ds_read_b128 v[52:55], v17 offset:960
    s_waitcnt lgkmcnt(8)
    v_mfma_f32_32x32x16_bf16 v[32:47], v[68:71], v[64:67], v[32:47]
    ds_read_b128 v[56:59], v11 offset:57344
    ds_read_b128 v[60:63], v17 offset:992
    s_waitcnt lgkmcnt(8)
    v_mfma_f32_32x32x16_bf16 v[32:47], v[76:79], v[72:75], v[32:47]
    s_waitcnt lgkmcnt(6)
    v_mfma_f32_32x32x16_bf16 v[32:47], v[84:87], v[80:83], v[32:47]
    s_waitcnt lgkmcnt(4)
    v_mfma_f32_32x32x16_bf16 v[32:47], v[92:95], v[88:91], v[32:47]
    s_waitcnt lgkmcnt(2)
    v_mfma_f32_32x32x16_bf16 v[32:47], v[52:55], v[48:51], v[32:47]
    s_waitcnt lgkmcnt(0)
    v_mfma_f32_32x32x16_bf16 v[32:47], v[60:63], v[56:59], v[32:47]
P1_NR10:
    s_waitcnt vmcnt(1)
    s_barrier
    s_mov_b32 s24, s84
    s_and_b32 s25, s85, 0xffff
    s_mov_b32 s26, 0x100
    s_mov_b32 s27, 0x00020000
    s_mov_b32 s94, 0
P1_TAGLL:
    s_waitcnt vmcnt(0)
    v_readfirstlane_b32 s95, v29
    s_add_u32 s94, s94, 1
    s_cmp_ge_u32 s94, 0x40000
    s_cbranch_scc1 P1_TAGLD
    s_cmp_lg_u32 s95, 0
    s_cbranch_scc1 P1_TAGLD
    buffer_load_dwordx2 v[28:29], off, s[24:27], 0 sc1
    s_branch P1_TAGLL
P1_TAGLD:
    v_readfirstlane_b32 s92, v28
    s_mov_b32 s39, -1
    s_cmp_lg_u32 s50, 0
    s_cbranch_scc1 P1_DONE
    s_nop 9
    s_lshl_b32 s39, s14, 1
    s_add_u32 s39, s39, s19
    v_cvt_pk_bf16_f32 v100, v32, v32
    v_lshlrev_b32 v100, 16, v100
    v_mul_f32 v100, 0xbfb8aa3b, v100
    v_exp_f32 v100, v100
    s_nop 0
    v_add_f32 v100, 1.0, v100
    v_rcp_f32 v100, v100
    s_nop 0
    v_cvt_pk_bf16_f32 v100, v100, v100
    v_lshlrev_b32 v100, 16, v100
    v_sub_f32 v101, 1.0, v100
    v_cvt_pk_bf16_f32 v101, v101, v101
    v_lshlrev_b32 v101, 16, v101
    v_cvt_pk_bf16_f32 v102, v33, v33
    v_lshlrev_b32 v102, 16, v102
    v_ashrrev_i32 v103, 31, v102
    v_or_b32 v103, 0x80000000, v103
    v_xor_b32 v102, v102, v103
    v_and_b32 v102, 0xffff0000, v102
    s_lshl_b32 s55, s39, 5
    v_add_u32 v103, s55, v6
    v_sub_u32 v103, 0xffff, v103
    v_or_b32 v102, v102, v103
    s_nop 1
    v_max_u32_dpp v102, v102, v102 row_ror:1 row_mask:0xf bank_mask:0xf
    s_nop 1
    v_max_u32_dpp v102, v102, v102 row_ror:2 row_mask:0xf bank_mask:0xf
    s_nop 1
    v_max_u32_dpp v102, v102, v102 row_ror:4 row_mask:0xf bank_mask:0xf
    s_nop 1
    v_max_u32_dpp v102, v102, v102 row_ror:8 row_mask:0xf bank_mask:0xf
    s_nop 0
    v_readlane_b32 s56, v102, 0
    v_readlane_b32 s57, v102, 16
    s_nop 3
    s_max_u32 s93, s56, s57
    s_lshl_b32 s54, s39, 8
    s_add_u32 s54, s54, 6725632
    v_lshlrev_b32 v27, 3, v6
    buffer_store_dwordx2 v[100:101], v27, s[88:91], s54 offen sc1
    v_mov_b64 v[84:85], 0
    v_lshlrev_b32 v27, 3, v0
    s_lshl_b32 s55, s39, 9
    s_add_u32 s55, s55, 6743040
    buffer_store_dwordx2 v[84:85], v27, s[88:91], s55 offen sc1
    s_branch P1_DONE
P1_COMPUTE:
    s_lshl_b32 s22, s2, 3
    s_add_u32 s22, s22, s19
    s_waitcnt lgkmcnt(0)
    s_mov_b32 s28, s66
    s_and_b32 s29, s67, 0xffff
    s_mov_b32 s30, 0x180000
    s_mov_b32 s31, 0x00020000
    s_mov_b32 s88, s86
    s_and_b32 s89, s87, 0xffff
    s_mov_b32 s90, 0x800000
    s_mov_b32 s91, 0x00020000
    s_mov_b32 s23, 6742016
    s_cmp_lg_u32 s22, 4
    s_cbranch_scc1 P1_NOEP0
    buffer_load_dword v24, off, s[88:91], s23 sc1
P1_NOEP0:
    s_mov_b32 s24, s84
    s_and_b32 s25, s85, 0xffff
    s_mov_b32 s26, 0x100
    s_mov_b32 s27, 0x00020000
    s_bfe_u32 s21, s19, 0x10001
    v_bfe_u32 v27, v0, 2, 2
    v_lshlrev_b32 v26, 7, v27
    v_lshrrev_b32 v27, 1, v27
    v_xor_b32 v27, s21, v27
    v_lshl_add_u32 v26, v27, 6, v26
    v_bfe_u32 v27, v0, 4, 1
    v_lshl_add_u32 v26, v27, 5, v26
    v_and_b32 v27, 3, v0
    v_lshl_add_u32 v26, v27, 3, v26
    v_add_u32 v26, 65536, v26
    v_lshl_add_u32 v16, v7, 11, v26
    v_lshl_add_u32 v17, v7, 10, v26
    s_cmp_lg_u32 s22, 4
    s_cbranch_scc1 P1_NOEP
    s_mov_b32 s22, 1664525
    v_mov_b32 v25, 1
    s_waitcnt vmcnt(0)
    v_mul_lo_u32 v24, v24, s22
    v_add_u32 v24, 1013904223, v24
    s_mov_b64 exec, 1
    buffer_store_dwordx2 v[24:25], off, s[24:27], 0 sc1
    buffer_store_dword v24, off, s[88:91], s23 sc1
    s_mov_b64 exec, -1
P1_NOEP:
    s_barrier
    ds_read_b128 v[120:123], v8 offset:0
    ds_read_b64_tr_b16 v[80:81], v16 offset:0
    ds_read_b64_tr_b16 v[82:83], v16 offset:512
    ds_read_b64_tr_b16 v[84:85], v16 offset:1024
    ds_read_b64_tr_b16 v[86:87], v16 offset:1536
    ds_read_b128 v[124:127], v9 offset:0
    ds_read_b64_tr_b16 v[88:89], v16 offset:4096
    ds_read_b64_tr_b16 v[90:91], v16 offset:4608
    ds_read_b64_tr_b16 v[92:93], v16 offset:5120
    ds_read_b64_tr_b16 v[94:95], v16 offset:5632
    s_cmp_lg_u32 s19, 5
    s_cbranch_scc1 P1_NOWQ
    s_and_b32 s46, s14, 31
    s_mul_i32 s46, s46, 49152
    s_lshl_b32 s47, s15, 7
    s_add_u32 s46, s46, s47
    v_and_b32 v24, 15, v0
    v_mul_u32_u24 v24, 3072, v24
    buffer_load_dword v28, v24, s[28:31], s46 offen
P1_NOWQ:
    s_waitcnt lgkmcnt(7)
    v_mfma_f32_32x32x16_bf16 v[32:47], v[80:83], v[120:123], 0
    ds_read_b128 v[128:131], v10 offset:0
    ds_read_b64_tr_b16 v[96:97], v16 offset:8192
    ds_read_b64_tr_b16 v[98:99], v16 offset:8704
    s_waitcnt lgkmcnt(8)
    v_mfma_f32_32x32x16_bf16 v[48:63], v[120:123], v[84:87], 0
    ds_read_b64_tr_b16 v[100:101], v16 offset:9216
    ds_read_b64_tr_b16 v[102:103], v16 offset:9728
    s_waitcnt lgkmcnt(7)
    v_mfma_f32_32x32x16_bf16 v[32:47], v[88:91], v[124:127], v[32:47]
    ds_read_b128 v[132:135], v11 offset:0
    ds_read_b64_tr_b16 v[80:81], v16 offset:12288
    ds_read_b64_tr_b16 v[82:83], v16 offset:12800
    s_waitcnt lgkmcnt(8)
    v_mfma_f32_32x32x16_bf16 v[48:63], v[124:127], v[92:95], v[48:63]
    ds_read_b64_tr_b16 v[84:85], v16 offset:13312
    ds_read_b64_tr_b16 v[86:87], v16 offset:13824
    s_waitcnt lgkmcnt(0)
    s_barrier
    v_mfma_f32_32x32x16_bf16 v[32:47], v[96:99], v[128:131], v[32:47]
    ds_read_b128 v[136:139], v8 offset:8192
    ds_read_b64_tr_b16 v[88:89], v16 offset:16384
    ds_read_b64_tr_b16 v[90:91], v16 offset:16896
    v_mfma_f32_32x32x16_bf16 v[48:63], v[128:131], v[100:103], v[48:63]
    ds_read_b64_tr_b16 v[92:93], v16 offset:17408
    ds_read_b64_tr_b16 v[94:95], v16 offset:17920
    v_mfma_f32_32x32x16_bf16 v[32:47], v[80:83], v[132:135], v[32:47]
    ds_read_b128 v[140:143], v9 offset:8192
    ds_read_b64_tr_b16 v[96:97], v16 offset:20480
    ds_read_b64_tr_b16 v[98:99], v16 offset:20992
    v_mfma_f32_32x32x16_bf16 v[48:63], v[132:135], v[84:87], v[48:63]
    ds_read_b64_tr_b16 v[100:101], v16 offset:21504
    ds_read_b64_tr_b16 v[102:103], v16 offset:22016
    s_waitcnt lgkmcnt(7)
    v_mfma_f32_32x32x16_bf16 v[32:47], v[88:91], v[136:139], v[32:47]
    ds_read_b128 v[144:147], v10 offset:8192
    ds_read_b64_tr_b16 v[80:81], v16 offset:24576
    ds_read_b64_tr_b16 v[82:83], v16 offset:25088
    s_waitcnt lgkmcnt(8)
    v_mfma_f32_32x32x16_bf16 v[48:63], v[136:139], v[92:95], v[48:63]
    ds_read_b64_tr_b16 v[84:85], v16 offset:25600
    ds_read_b64_tr_b16 v[86:87], v16 offset:26112
    s_waitcnt lgkmcnt(7)
    v_mfma_f32_32x32x16_bf16 v[32:47], v[96:99], v[140:143], v[32:47]
    ds_read_b128 v[148:151], v11 offset:8192
    ds_read_b64_tr_b16 v[88:89], v16 offset:28672
    ds_read_b64_tr_b16 v[90:91], v16 offset:29184
    s_waitcnt lgkmcnt(8)
    v_mfma_f32_32x32x16_bf16 v[48:63], v[140:143], v[100:103], v[48:63]
    ds_read_b64_tr_b16 v[92:93], v16 offset:29696
    ds_read_b64_tr_b16 v[94:95], v16 offset:30208
    s_waitcnt lgkmcnt(0)
    s_barrier
    v_mfma_f32_32x32x16_bf16 v[32:47], v[80:83], v[144:147], v[32:47]
    ds_read_b128 v[152:155], v8 offset:16384
    ds_read_b64_tr_b16 v[96:97], v16 offset:32768
    ds_read_b64_tr_b16 v[98:99], v16 offset:33280
    v_mfma_f32_32x32x16_bf16 v[48:63], v[144:147], v[84:87], v[48:63]
    ds_read_b64_tr_b16 v[100:101], v16 offset:33792
    ds_read_b64_tr_b16 v[102:103], v16 offset:34304
    v_mfma_f32_32x32x16_bf16 v[32:47], v[88:91], v[148:151], v[32:47]
    ds_read_b128 v[156:159], v9 offset:16384
    ds_read_b64_tr_b16 v[80:81], v16 offset:36864
    ds_read_b64_tr_b16 v[82:83], v16 offset:37376
    v_mfma_f32_32x32x16_bf16 v[48:63], v[148:151], v[92:95], v[48:63]
    ds_read_b64_tr_b16 v[84:85], v16 offset:37888
    ds_read_b64_tr_b16 v[86:87], v16 offset:38400
    s_waitcnt lgkmcnt(7)
    v_mfma_f32_32x32x16_bf16 v[32:47], v[96:99], v[152:155], v[32:47]
    ds_read_b128 v[160:163], v10 offset:16384
    ds_read_b64_tr_b16 v[88:89], v16 offset:40960
    ds_read_b64_tr_b16 v[90:91], v16 offset:41472
    s_waitcnt lgkmcnt(8)
    v_mfma_f32_32x32x16_bf16 v[48:63], v[152:155], v[100:103], v[48:63]
    ds_read_b64_tr_b16 v[92:93], v16 offset:41984
    ds_read_b64_tr_b16 v[94:95], v16 offset:42496
    s_waitcnt lgkmcnt(7)
    v_mfma_f32_32x32x16_bf16 v[32:47], v[80:83], v[156:159], v[32:47]
    ds_read_b128 v[164:167], v11 offset:16384
    ds_read_b64_tr_b16 v[96:97], v16 offset:45056
    ds_read_b64_tr_b16 v[98:99], v16 offset:45568
    s_waitcnt lgkmcnt(8)
    v_mfma_f32_32x32x16_bf16 v[48:63], v[156:159], v[84:87], v[48:63]
    ds_read_b64_tr_b16 v[100:101], v16 offset:46080
    ds_read_b64_tr_b16 v[102:103], v16 offset:46592
    s_waitcnt lgkmcnt(0)
    s_barrier
    v_mfma_f32_32x32x16_bf16 v[32:47], v[88:91], v[160:163], v[32:47]
    ds_read_b128 v[168:171], v8 offset:24576
    ds_read_b64_tr_b16 v[80:81], v16 offset:49152
    ds_read_b64_tr_b16 v[82:83], v16 offset:49664
    v_mfma_f32_32x32x16_bf16 v[48:63], v[160:163], v[92:95], v[48:63]
    ds_read_b64_tr_b16 v[84:85], v16 offset:50176
    ds_read_b64_tr_b16 v[86:87], v16 offset:50688
    v_mfma_f32_32x32x16_bf16 v[32:47], v[96:99], v[164:167], v[32:47]
    ds_read_b128 v[172:175], v9 offset:24576
    ds_read_b64_tr_b16 v[88:89], v16 offset:53248
    ds_read_b64_tr_b16 v[90:91], v16 offset:53760
    v_mfma_f32_32x32x16_bf16 v[48:63], v[164:167], v[100:103], v[48:63]
    ds_read_b64_tr_b16 v[92:93], v16 offset:54272
    ds_read_b64_tr_b16 v[94:95], v16 offset:54784
    s_waitcnt lgkmcnt(7)
    v_mfma_f32_32x32x16_bf16 v[32:47], v[80:83], v[168:171], v[32:47]
    ds_read_b128 v[176:179], v10 offset:24576
    ds_read_b64_tr_b16 v[96:97], v16 offset:57344
    ds_read_b64_tr_b16 v[98:99], v16 offset:57856
    s_waitcnt lgkmcnt(8)
    v_mfma_f32_32x32x16_bf16 v[48:63], v[168:171], v[84:87], v[48:63]
    ds_read_b64_tr_b16 v[100:101], v16 offset:58368
    ds_read_b64_tr_b16 v[102:103], v16 offset:58880
    s_waitcnt lgkmcnt(7)
    v_mfma_f32_32x32x16_bf16 v[32:47], v[88:91], v[172:175], v[32:47]
    ds_read_b128 v[180:183], v11 offset:24576
    ds_read_b64_tr_b16 v[80:81], v16 offset:61440
    ds_read_b64_tr_b16 v[82:83], v16 offset:61952
    s_waitcnt lgkmcnt(8)
    v_mfma_f32_32x32x16_bf16 v[48:63], v[172:175], v[92:95], v[48:63]
    ds_read_b64_tr_b16 v[84:85], v16 offset:62464
    ds_read_b64_tr_b16 v[86:87], v16 offset:62976
    s_waitcnt lgkmcnt(0)
    s_barrier
    v_mfma_f32_32x32x16_bf16 v[32:47], v[96:99], v[176:179], v[32:47]
    ds_read_b128 v[184:187], v8 offset:32768
    ds_read_b64_tr_b16 v[88:89], v16 offset:0
    ds_read_b64_tr_b16 v[90:91], v16 offset:512
    v_mfma_f32_32x32x16_bf16 v[48:63], v[176:179], v[100:103], v[48:63]
    ds_read_b64_tr_b16 v[92:93], v16 offset:1024
    ds_read_b64_tr_b16 v[94:95], v16 offset:1536
    v_mfma_f32_32x32x16_bf16 v[32:47], v[80:83], v[180:183], v[32:47]
    ds_read_b128 v[188:191], v9 offset:32768
    ds_read_b64_tr_b16 v[96:97], v16 offset:4096
    ds_read_b64_tr_b16 v[98:99], v16 offset:4608
    v_mfma_f32_32x32x16_bf16 v[48:63], v[180:183], v[84:87], v[48:63]
    ds_read_b64_tr_b16 v[100:101], v16 offset:5120
    ds_read_b64_tr_b16 v[102:103], v16 offset:5632
    s_waitcnt lgkmcnt(7)
    v_mfma_f32_32x32x16_bf16 v[32:47], v[88:91], v[184:187], v[32:47]
    ds_read_b128 v[192:195], v10 offset:32768
    ds_read_b64_tr_b16 v[80:81], v16 offset:8192
    ds_read_b64_tr_b16 v[82:83], v16 offset:8704
    s_waitcnt lgkmcnt(8)
    v_mfma_f32_32x32x16_bf16 v[48:63], v[184:187], v[92:95], v[48:63]
    ds_read_b64_tr_b16 v[84:85], v16 offset:9216
    ds_read_b64_tr_b16 v[86:87], v16 offset:9728
    s_waitcnt lgkmcnt(7)
    v_mfma_f32_32x32x16_bf16 v[32:47], v[96:99], v[188:191], v[32:47]
    ds_read_b128 v[196:199], v11 offset:32768
    ds_read_b64_tr_b16 v[88:89], v16 offset:12288
    ds_read_b64_tr_b16 v[90:91], v16 offset:12800
    s_waitcnt lgkmcnt(8)
    v_mfma_f32_32x32x16_bf16 v[48:63], v[188:191], v[100:103], v[48:63]
    ds_read_b64_tr_b16 v[92:93], v16 offset:13312
    ds_read_b64_tr_b16 v[94:95], v16 offset:13824
    s_waitcnt lgkmcnt(0)
    s_barrier
    v_mfma_f32_32x32x16_bf16 v[32:47], v[80:83], v[192:195], v[32:47]
    ds_read_b128 v[200:203], v8 offset:40960
    ds_read_b64_tr_b16 v[96:97], v16 offset:16384
    ds_read_b64_tr_b16 v[98:99], v16 offset:16896
    v_mfma_f32_32x32x16_bf16 v[48:63], v[192:195], v[84:87], v[48:63]
    ds_read_b64_tr_b16 v[100:101], v16 offset:17408
    ds_read_b64_tr_b16 v[102:103], v16 offset:17920
    v_mfma_f32_32x32x16_bf16 v[32:47], v[88:91], v[196:199], v[32:47]
    ds_read_b128 v[204:207], v9 offset:40960
    ds_read_b64_tr_b16 v[80:81], v16 offset:20480
    ds_read_b64_tr_b16 v[82:83], v16 offset:20992
    v_mfma_f32_32x32x16_bf16 v[48:63], v[196:199], v[92:95], v[48:63]
    ds_read_b64_tr_b16 v[84:85], v16 offset:21504
    ds_read_b64_tr_b16 v[86:87], v16 offset:22016
    s_waitcnt lgkmcnt(7)
    v_mfma_f32_32x32x16_bf16 v[32:47], v[96:99], v[200:203], v[32:47]
    ds_read_b128 v[208:211], v10 offset:40960
    ds_read_b64_tr_b16 v[88:89], v16 offset:24576
    ds_read_b64_tr_b16 v[90:91], v16 offset:25088
    s_waitcnt lgkmcnt(8)
    v_mfma_f32_32x32x16_bf16 v[48:63], v[200:203], v[100:103], v[48:63]
    ds_read_b64_tr_b16 v[92:93], v16 offset:25600
    ds_read_b64_tr_b16 v[94:95], v16 offset:26112
    s_waitcnt lgkmcnt(7)
    v_mfma_f32_32x32x16_bf16 v[32:47], v[80:83], v[204:207], v[32:47]
    ds_read_b128 v[212:215], v11 offset:40960
    ds_read_b64_tr_b16 v[96:97], v16 offset:28672
    ds_read_b64_tr_b16 v[98:99], v16 offset:29184
    s_waitcnt lgkmcnt(8)
    v_mfma_f32_32x32x16_bf16 v[48:63], v[204:207], v[84:87], v[48:63]
    ds_read_b64_tr_b16 v[100:101], v16 offset:29696
    ds_read_b64_tr_b16 v[102:103], v16 offset:30208
    s_waitcnt lgkmcnt(0)
    s_barrier
    v_mfma_f32_32x32x16_bf16 v[32:47], v[88:91], v[208:211], v[32:47]
    ds_read_b128 v[216:219], v8 offset:49152
    ds_read_b64_tr_b16 v[80:81], v16 offset:32768
    ds_read_b64_tr_b16 v[82:83], v16 offset:33280
    v_mfma_f32_32x32x16_bf16 v[48:63], v[208:211], v[92:95], v[48:63]
    ds_read_b64_tr_b16 v[84:85], v16 offset:33792
    ds_read_b64_tr_b16 v[86:87], v16 offset:34304
    v_mfma_f32_32x32x16_bf16 v[32:47], v[96:99], v[212:215], v[32:47]
    ds_read_b128 v[220:223], v9 offset:49152
    ds_read_b64_tr_b16 v[88:89], v16 offset:36864
    ds_read_b64_tr_b16 v[90:91], v16 offset:37376
    v_mfma_f32_32x32x16_bf16 v[48:63], v[212:215], v[100:103], v[48:63]
    ds_read_b64_tr_b16 v[92:93], v16 offset:37888
    ds_read_b64_tr_b16 v[94:95], v16 offset:38400
    s_waitcnt lgkmcnt(7)
    v_mfma_f32_32x32x16_bf16 v[32:47], v[80:83], v[216:219], v[32:47]
    ds_read_b128 v[224:227], v10 offset:49152
    ds_read_b64_tr_b16 v[96:97], v16 offset:40960
    ds_read_b64_tr_b16 v[98:99], v16 offset:41472
    s_waitcnt lgkmcnt(8)
    v_mfma_f32_32x32x16_bf16 v[48:63], v[216:219], v[84:87], v[48:63]
    ds_read_b64_tr_b16 v[100:101], v16 offset:41984
    ds_read_b64_tr_b16 v[102:103], v16 offset:42496
    s_waitcnt lgkmcnt(7)
    v_mfma_f32_32x32x16_bf16 v[32:47], v[88:91], v[220:223], v[32:47]
    ds_read_b128 v[228:231], v11 offset:49152
    ds_read_b64_tr_b16 v[80:81], v16 offset:45056
    ds_read_b64_tr_b16 v[82:83], v16 offset:45568
    s_waitcnt lgkmcnt(8)
    v_mfma_f32_32x32x16_bf16 v[48:63], v[220:223], v[92:95], v[48:63]
    ds_read_b64_tr_b16 v[84:85], v16 offset:46080
    ds_read_b64_tr_b16 v[86:87], v16 offset:46592
    s_waitcnt lgkmcnt(0)
    s_barrier
    v_mfma_f32_32x32x16_bf16 v[32:47], v[96:99], v[224:227], v[32:47]
    ds_read_b128 v[232:235], v8 offset:57344
    ds_read_b64_tr_b16 v[88:89], v16 offset:49152
    ds_read_b64_tr_b16 v[90:91], v16 offset:49664
    v_mfma_f32_32x32x16_bf16 v[48:63], v[224:227], v[100:103], v[48:63]
    ds_read_b64_tr_b16 v[92:93], v16 offset:50176
    ds_read_b64_tr_b16 v[94:95], v16 offset:50688
    v_mfma_f32_32x32x16_bf16 v[32:47], v[80:83], v[228:231], v[32:47]
    ds_read_b128 v[236:239], v9 offset:57344
    ds_read_b64_tr_b16 v[96:97], v16 offset:53248
    ds_read_b64_tr_b16 v[98:99], v16 offset:53760
    v_mfma_f32_32x32x16_bf16 v[48:63], v[228:231], v[84:87], v[48:63]
    ds_read_b64_tr_b16 v[100:101], v16 offset:54272
    ds_read_b64_tr_b16 v[102:103], v16 offset:54784
    s_waitcnt lgkmcnt(7)
    v_mfma_f32_32x32x16_bf16 v[32:47], v[88:91], v[232:235], v[32:47]
    ds_read_b128 v[240:243], v10 offset:57344
    ds_read_b64_tr_b16 v[80:81], v16 offset:57344
    ds_read_b64_tr_b16 v[82:83], v16 offset:57856
    s_waitcnt lgkmcnt(8)
    v_mfma_f32_32x32x16_bf16 v[48:63], v[232:235], v[92:95], v[48:63]
    ds_read_b64_tr_b16 v[84:85], v16 offset:58368
    ds_read_b64_tr_b16 v[86:87], v16 offset:58880
    s_waitcnt lgkmcnt(7)
    v_mfma_f32_32x32x16_bf16 v[32:47], v[96:99], v[236:239], v[32:47]
    ds_read_b128 v[244:247], v11 offset:57344
    ds_read_b64_tr_b16 v[88:89], v16 offset:61440
    ds_read_b64_tr_b16 v[90:91], v16 offset:61952
    s_waitcnt lgkmcnt(8)
    v_mfma_f32_32x32x16_bf16 v[48:63], v[236:239], v[100:103], v[48:63]
    ds_read_b64_tr_b16 v[92:93], v16 offset:62464
    ds_read_b64_tr_b16 v[94:95], v16 offset:62976
    s_waitcnt lgkmcnt(7)
    v_mfma_f32_32x32x16_bf16 v[32:47], v[80:83], v[240:243], v[32:47]
    s_waitcnt lgkmcnt(5)
    v_mfma_f32_32x32x16_bf16 v[48:63], v[240:243], v[84:87], v[48:63]
    s_waitcnt lgkmcnt(2)
    v_mfma_f32_32x32x16_bf16 v[32:47], v[88:91], v[244:247], v[32:47]
    s_waitcnt lgkmcnt(0)
    v_mfma_f32_32x32x16_bf16 v[48:63], v[244:247], v[92:95], v[48:63]
    s_barrier
    ds_read_b64_tr_b16 v[80:81], v17 offset:0
    ds_read_b64_tr_b16 v[82:83], v17 offset:512
    ds_read_b64_tr_b16 v[84:85], v17 offset:2048
    ds_read_b64_tr_b16 v[86:87], v17 offset:2560
    ds_read_b64_tr_b16 v[88:89], v17 offset:4096
    ds_read_b64_tr_b16 v[90:91], v17 offset:4608
    ds_read_b64_tr_b16 v[92:93], v17 offset:6144
    ds_read_b64_tr_b16 v[94:95], v17 offset:6656
    ds_read_b64_tr_b16 v[96:97], v17 offset:8192
    ds_read_b64_tr_b16 v[98:99], v17 offset:8704
    s_lshl_b32 s46, s15, 1
    s_add_u32 s46, s46, s21
    s_lshl_b32 s48, s46, 18
    s_lshl_b32 s49, s20, 16
    s_add_u32 s48, s48, s49
    s_lshl_b32 s49, s14, 11
    s_add_u32 s48, s48, s49
    s_add_u32 s49, s48, 131072
    v_lshrrev_b32 v24, 4, v6
    v_lshlrev_b32 v24, 17, v24
    v_lshl_add_u32 v24, v7, 8, v24
    v_and_b32 v25, 15, v0
    v_lshl_add_u32 v24, v25, 4, v24
    v_cvt_pk_bf16_f32 v104, v32, v33
    v_cvt_pk_bf16_f32 v105, v34, v35
    v_cvt_pk_bf16_f32 v106, v36, v37
    v_cvt_pk_bf16_f32 v107, v38, v39
    v_cvt_pk_bf16_f32 v108, v40, v41
    v_cvt_pk_bf16_f32 v109, v42, v43
    v_cvt_pk_bf16_f32 v110, v44, v45
    v_cvt_pk_bf16_f32 v111, v46, v47
    buffer_store_dwordx4 v[104:107], v2, s[88:91], s48 offen sc1
    buffer_store_dwordx4 v[108:111], v2, s[88:91], s49 offen sc1
    v_cvt_pk_bf16_f32 v112, v48, v49
    v_cvt_pk_bf16_f32 v113, v50, v51
    v_cvt_pk_bf16_f32 v114, v52, v53
    v_cvt_pk_bf16_f32 v115, v54, v55
    v_cvt_pk_bf16_f32 v116, v56, v57
    v_cvt_pk_bf16_f32 v117, v58, v59
    v_cvt_pk_bf16_f32 v118, v60, v61
    v_cvt_pk_bf16_f32 v119, v62, v63
    v_permlane32_swap_b32 v112, v114
    v_permlane32_swap_b32 v113, v115
    v_permlane32_swap_b32 v116, v118
    v_permlane32_swap_b32 v117, v119
    buffer_store_dwordx4 v[112:115], v24, s[88:91], s48 offen offset:1024 sc1
    buffer_store_dwordx4 v[116:119], v24, s[88:91], s48 offen offset:1536 sc1
    buffer_load_dwordx2 v[28:29], off, s[24:27], 0 sc1
    s_lshl_b32 s50, s21, 13
    s_lshl_b32 s51, s20, 11
    s_add_u32 s50, s50, s51
    s_add_u32 s50, s50, 131072
    v_add_u32 v26, s50, v2
    v_lshrrev_b32 v27, 5, v24
    v_and_b32 v27, 4096, v27
    v_and_b32 v25, 1023, v24
    v_add3_u32 v27, v27, v25, s50
    ds_write_b128 v26, v[104:107]
    ds_write_b128 v26, v[108:111] offset:4096
    ds_write_b128 v27, v[112:115] offset:1024
    ds_write_b128 v27, v[116:119] offset:1536
    s_lshl_b32 s96, s15, 12
    s_lshl_b32 s97, s14, 7
    s_add_u32 s96, s96, s97
    s_add_u32 s96, s96, 6356992
    s_waitcnt lgkmcnt(12)
    v_mfma_f32_32x32x16_bf16 v[64:79], v[80:83], v[120:123], 0
    ds_read_b64_tr_b16 v[100:101], v17 offset:10240
    ds_read_b64_tr_b16 v[102:103], v17 offset:10752
    s_waitcnt lgkmcnt(12)
    v_mfma_f32_32x32x16_bf16 v[64:79], v[84:87], v[124:127], v[64:79]
    ds_read_b64_tr_b16 v[80:81], v17 offset:12288
    ds_read_b64_tr_b16 v[82:83], v17 offset:12800
    s_waitcnt lgkmcnt(12)
    v_mfma_f32_32x32x16_bf16 v[64:79], v[88:91], v[128:131], v[64:79]
    ds_read_b64_tr_b16 v[84:85], v17 offset:14336
    ds_read_b64_tr_b16 v[86:87], v17 offset:14848
    s_waitcnt lgkmcnt(12)
    v_mfma_f32_32x32x16_bf16 v[64:79], v[92:95], v[132:135], v[64:79]
    s_barrier
    ds_read_b64_tr_b16 v[88:89], v17 offset:16384
    ds_read_b64_tr_b16 v[90:91], v17 offset:16896
    s_waitcnt lgkmcnt(12)
    v_mfma_f32_32x32x16_bf16 v[64:79], v[96:99], v[136:139], v[64:79]
    ds_read_b64_tr_b16 v[92:93], v17 offset:18432
    ds_read_b64_tr_b16 v[94:95], v17 offset:18944
    s_waitcnt lgkmcnt(8)
    v_mfma_f32_32x32x16_bf16 v[64:79], v[100:103], v[140:143], v[64:79]
    ds_read_b64_tr_b16 v[96:97], v17 offset:20480
    ds_read_b64_tr_b16 v[98:99], v17 offset:20992
    s_waitcnt lgkmcnt(8)
    v_mfma_f32_32x32x16_bf16 v[64:79], v[80:83], v[144:147], v[64:79]
    ds_read_b64_tr_b16 v[100:101], v17 offset:22528
    ds_read_b64_tr_b16 v[102:103], v17 offset:23040
    s_waitcnt lgkmcnt(8)
    v_mfma_f32_32x32x16_bf16 v[64:79], v[84:87], v[148:151], v[64:79]
    ds_read_b64_tr_b16 v[80:81], v17 offset:24576
    ds_read_b64_tr_b16 v[82:83], v17 offset:25088
    s_waitcnt lgkmcnt(8)
    v_mfma_f32_32x32x16_bf16 v[64:79], v[88:91], v[152:155], v[64:79]
    ds_read_b64_tr_b16 v[84:85], v17 offset:26624
    ds_read_b64_tr_b16 v[86:87], v17 offset:27136
    s_waitcnt lgkmcnt(8)
    v_mfma_f32_32x32x16_bf16 v[64:79], v[92:95], v[156:159], v[64:79]
    ds_read_b64_tr_b16 v[88:89], v17 offset:28672
    ds_read_b64_tr_b16 v[90:91], v17 offset:29184
    s_waitcnt lgkmcnt(8)
    v_mfma_f32_32x32x16_bf16 v[64:79], v[96:99], v[160:163], v[64:79]
    ds_read_b64_tr_b16 v[92:93], v17 offset:30720
    ds_read_b64_tr_b16 v[94:95], v17 offset:31232
    s_waitcnt lgkmcnt(8)
    v_mfma_f32_32x32x16_bf16 v[64:79], v[100:103], v[164:167], v[64:79]
    s_barrier
    ds_read_b64_tr_b16 v[96:97], v17 offset:32768
    ds_read_b64_tr_b16 v[98:99], v17 offset:33280
    s_waitcnt lgkmcnt(8)
    v_mfma_f32_32x32x16_bf16 v[64:79], v[80:83], v[168:171], v[64:79]
    ds_read_b64_tr_b16 v[100:101], v17 offset:34816
    ds_read_b64_tr_b16 v[102:103], v17 offset:35328
    s_waitcnt lgkmcnt(8)
    v_mfma_f32_32x32x16_bf16 v[64:79], v[84:87], v[172:175], v[64:79]
    ds_read_b64_tr_b16 v[80:81], v17 offset:36864
    ds_read_b64_tr_b16 v[82:83], v17 offset:37376
    s_waitcnt lgkmcnt(8)
    v_mfma_f32_32x32x16_bf16 v[64:79], v[88:91], v[176:179], v[64:79]
    ds_read_b64_tr_b16 v[84:85], v17 offset:38912
    ds_read_b64_tr_b16 v[86:87], v17 offset:39424
    s_waitcnt lgkmcnt(8)
    v_mfma_f32_32x32x16_bf16 v[64:79], v[92:95], v[180:183], v[64:79]
    ds_read_b64_tr_b16 v[88:89], v17 offset:40960
    ds_read_b64_tr_b16 v[90:91], v17 offset:41472
    s_waitcnt lgkmcnt(8)
    v_mfma_f32_32x32x16_bf16 v[64:79], v[96:99], v[184:187], v[64:79]
    ds_read_b64_tr_b16 v[92:93], v17 offset:43008
    ds_read_b64_tr_b16 v[94:95], v17 offset:43520
    s_waitcnt lgkmcnt(8)
    v_mfma_f32_32x32x16_bf16 v[64:79], v[100:103], v[188:191], v[64:79]
    ds_read_b64_tr_b16 v[96:97], v17 offset:45056
    ds_read_b64_tr_b16 v[98:99], v17 offset:45568
    s_waitcnt lgkmcnt(8)
    v_mfma_f32_32x32x16_bf16 v[64:79], v[80:83], v[192:195], v[64:79]
    ds_read_b64_tr_b16 v[100:101], v17 offset:47104
    ds_read_b64_tr_b16 v[102:103], v17 offset:47616
    s_waitcnt lgkmcnt(8)
    v_mfma_f32_32x32x16_bf16 v[64:79], v[84:87], v[196:199], v[64:79]
    s_barrier
    ds_read_b64_tr_b16 v[80:81], v17 offset:49152
    ds_read_b64_tr_b16 v[82:83], v17 offset:49664
    s_mov_b32 s94, 0
P1_TAGCL:
    s_waitcnt vmcnt(0)
    v_readfirstlane_b32 s95, v29
    s_add_u32 s94, s94, 1
    s_cmp_ge_u32 s94, 0x40000
    s_cbranch_scc1 P1_TAGCD
    s_cmp_lg_u32 s95, 0
    s_cbranch_scc1 P1_TAGCD
    buffer_load_dwordx2 v[28:29], off, s[24:27], 0 sc1
    s_branch P1_TAGCL
P1_TAGCD:
    v_readfirstlane_b32 s92, v28
    v_mov_b32 v30, 1
    s_mov_b64 exec, 1
    ds_add_rtn_u32 v30, v254, v30 offset:0
    s_waitcnt lgkmcnt(0)
    v_readfirstlane_b32 s97, v30
    v_mov_b32 v30, s92
    s_nop 1
    s_cmp_lg_u32 s97, 3
    s_cbranch_scc1 P1_FL
    buffer_store_dword v30, off, s[88:91], s96 sc1
P1_FL:
    s_mov_b64 exec, -1
    v_mfma_f32_32x32x16_bf16 v[64:79], v[88:91], v[200:203], v[64:79]
    ds_read_b64_tr_b16 v[84:85], v17 offset:51200
    ds_read_b64_tr_b16 v[86:87], v17 offset:51712
    v_mfma_f32_32x32x16_bf16 v[64:79], v[92:95], v[204:207], v[64:79]
    ds_read_b64_tr_b16 v[88:89], v17 offset:53248
    ds_read_b64_tr_b16 v[90:91], v17 offset:53760
    v_mfma_f32_32x32x16_bf16 v[64:79], v[96:99], v[208:211], v[64:79]
    ds_read_b64_tr_b16 v[92:93], v17 offset:55296
    ds_read_b64_tr_b16 v[94:95], v17 offset:55808
    v_mfma_f32_32x32x16_bf16 v[64:79], v[100:103], v[212:215], v[64:79]
    ds_read_b64_tr_b16 v[96:97], v17 offset:57344
    ds_read_b64_tr_b16 v[98:99], v17 offset:57856
    v_mfma_f32_32x32x16_bf16 v[64:79], v[80:83], v[216:219], v[64:79]
    ds_read_b64_tr_b16 v[100:101], v17 offset:59392
    ds_read_b64_tr_b16 v[102:103], v17 offset:59904
    s_waitcnt lgkmcnt(8)
    v_mfma_f32_32x32x16_bf16 v[64:79], v[84:87], v[220:223], v[64:79]
    ds_read_b64_tr_b16 v[80:81], v17 offset:61440
    ds_read_b64_tr_b16 v[82:83], v17 offset:61952
    s_waitcnt lgkmcnt(8)
    v_mfma_f32_32x32x16_bf16 v[64:79], v[88:91], v[224:227], v[64:79]
    ds_read_b64_tr_b16 v[84:85], v17 offset:63488
    ds_read_b64_tr_b16 v[86:87], v17 offset:64000
    s_waitcnt lgkmcnt(8)
    v_mfma_f32_32x32x16_bf16 v[64:79], v[92:95], v[228:231], v[64:79]
    s_waitcnt lgkmcnt(6)
    v_mfma_f32_32x32x16_bf16 v[64:79], v[96:99], v[232:235], v[64:79]
    s_waitcnt lgkmcnt(4)
    v_mfma_f32_32x32x16_bf16 v[64:79], v[100:103], v[236:239], v[64:79]
    s_waitcnt lgkmcnt(2)
    v_mfma_f32_32x32x16_bf16 v[64:79], v[80:83], v[240:243], v[64:79]
    s_waitcnt lgkmcnt(0)
    v_mfma_f32_32x32x16_bf16 v[64:79], v[84:87], v[244:247], v[64:79]
    s_mov_b32 s54, 0x3eb8aa3b
    s_mov_b32 s55, 0x3eb8aa3b
    s_lshl_b32 s22, s21, 12
    s_lshl_b32 s23, s20, 10
    s_add_u32 s22, s22, s23
    s_add_u32 s22, s22, 153600
    v_add_u32 v24, s22, v2
    s_lshl_b32 s22, s21, 9
    s_lshl_b32 s23, s20, 7
    s_add_u32 s22, s22, s23
    s_add_u32 s22, s22, 161792
    v_lshl_add_u32 v26, v6, 2, s22
    v_lshl_add_u32 v26, v7, 8, v26
    v_pk_mul_f32 v[64:65], v[64:65], s[54:55]
    v_pk_mul_f32 v[66:67], v[66:67], s[54:55]
    v_pk_mul_f32 v[68:69], v[68:69], s[54:55]
    v_pk_mul_f32 v[70:71], v[70:71], s[54:55]
    v_pk_mul_f32 v[72:73], v[72:73], s[54:55]
    v_pk_mul_f32 v[74:75], v[74:75], s[54:55]
    v_pk_mul_f32 v[76:77], v[76:77], s[54:55]
    v_pk_mul_f32 v[78:79], v[78:79], s[54:55]
    v_cvt_pk_bf16_f32 v80, v64, v65
    v_cvt_pk_bf16_f32 v81, v66, v67
    v_cvt_pk_bf16_f32 v82, v68, v69
    v_cvt_pk_bf16_f32 v83, v70, v71
    v_cvt_pk_bf16_f32 v84, v72, v73
    v_cvt_pk_bf16_f32 v85, v74, v75
    v_cvt_pk_bf16_f32 v86, v76, v77
    v_cvt_pk_bf16_f32 v87, v78, v79
    s_nop 1
    v_mfma_f32_32x32x16_bf16 v[32:47], v[104:107], v[80:83], 0
    v_mfma_f32_32x32x16_bf16 v[48:63], v[108:111], v[84:87], 0
    ds_write_b128 v24, v[80:83]
    ds_write_b128 v24, v[84:87] offset:2048
    s_nop 9
    v_max3_f32 v92, v32, v33, v34
    v_max3_f32 v92, v92, v35, v36
    v_max3_f32 v92, v92, v37, v38
    v_max3_f32 v92, v92, v39, v40
    v_max3_f32 v92, v92, v41, v42
    v_max3_f32 v92, v92, v43, v44
    v_max3_f32 v92, v92, v45, v46
    v_max_f32 v92, v92, v47
    v_max3_f32 v93, v48, v49, v50
    v_max3_f32 v93, v93, v51, v52
    v_max3_f32 v93, v93, v53, v54
    v_max3_f32 v93, v93, v55, v56
    v_max3_f32 v93, v93, v57, v58
    v_max3_f32 v93, v93, v59, v60
    v_max3_f32 v93, v93, v61, v62
    v_max_f32 v93, v93, v63
    s_nop 1
    v_permlane32_swap_b32 v92, v93
    v_max_f32 v92, v92, v93
    v_sub_f32 v92, 0, v92
    ds_write_b32 v26, v92
P1_DONE:
    s_and_b32 s17, s19, 3
    s_lshr_b32 s16, s19, 2
    v_and_b32 v3, 15, v0
    v_lshlrev_b32 v3, 4, v3
    v_lshl_add_u32 v3, v7, 8, v3
    s_lshl_b32 s18, s15, 2
    s_add_u32 s18, s18, s17
    s_lshl_b32 s22, s18, 17
    s_lshl_b32 s23, s16, 16
    s_add_u32 s22, s22, s23
    v_add_u32 v196, s22, v2
    v_add_u32 v197, s22, v3
    s_lshl_b32 s23, s17, 12
    s_lshl_b32 s28, s16, 11
    s_add_u32 s23, s23, s28
    s_add_u32 s23, s23, 131072
    v_add_u32 v248, s23, v2
    v_add_u32 v249, s23, v3
    s_lshl_b32 s95, s15, 12
    s_add_u32 s95, s95, 6356992
    s_mov_b32 s30, 0x0000ffff
    s_mov_b32 s31, 0x0000ffff
    s_mov_b32 s29, 0
    s_cmp_lt_u32 s19, 4
    s_cselect_b32 s32, 0xff, 0
    s_mov_b32 s40, s68
    s_and_b32 s41, s69, 0xffff
    s_mov_b32 s42, 0x80000
    s_mov_b32 s43, 0x00020000
    v_lshrrev_b32 v4, 3, v0
    v_lshlrev_b32 v4, 10, v4
    v_and_b32 v5, 7, v0
    v_bfe_u32 v192, v0, 4, 1
    v_lshlrev_b32 v192, 2, v192
    v_xor_b32 v5, v5, v192
    v_lshl_add_u32 v4, v5, 4, v4
    s_lshl_b32 s36, s63, 7
    s_lshl_b32 s37, s19, 13
    s_add_u32 s36, s36, s37
    s_lshl_b32 s37, s19, 10
    s_add_u32 s37, s37, 65536
    s_mul_i32 s23, s19, 2304
    s_add_u32 s23, s23, 131072
    v_add_u32 v168, s23, v2
    v_lshl_add_u32 v169, v0, 2, s23
    s_xor_b32 s23, s19, 4
    s_mul_i32 s23, s23, 2304
    s_add_u32 s23, s23, 131072
    v_add_u32 v170, s23, v2
    v_lshl_add_u32 v171, v0, 2, s23
    s_lshl_b32 s23, s14, 1
    s_add_u32 s23, s23, s16
    s_lshl_b32 s33, s23, 15
    s_lshl_b32 s23, s18, 10
    s_add_u32 s33, s33, s23
    s_add_u32 s33, s33, 4259840
    s_lshl_b32 s98, s14, 10
    s_lshl_b32 s23, s15, 7
    s_add_u32 s98, s98, s23
    s_add_u32 s98, s98, 6389760
    s_and_b32 s8, s19, 1
    s_bfe_u32 s9, s19, 0x10001
    s_lshl_b32 s4, s62, 1
    s_add_u32 s4, s4, s8
    s_lshl_b32 s5, s63, 7
    s_lshl_b32 s23, s9, 6
    s_add_u32 s5, s5, s23
    s_lshl_b32 s6, s4, 15
    s_add_u32 s6, s6, s5
    s_lshl_b32 s7, s4, 8
    s_add_u32 s7, s7, 6725632
    v_lshlrev_b32 v172, 10, v6
    v_lshl_add_u32 v172, v7, 5, v172
    v_bfe_u32 v193, v0, 2, 2
    v_lshl_add_u32 v192, v7, 2, v193
    v_lshlrev_b32 v192, 7, v192
    v_lshrrev_b32 v193, 1, v193
    v_xor_b32 v193, s9, v193
    v_lshl_add_u32 v192, v193, 6, v192
    v_and_b32 v193, 1, v0
    v_lshl_add_u32 v192, v193, 5, v192
    v_bfe_u32 v193, v0, 1, 1
    v_bfe_u32 v194, v0, 4, 1
    v_lshl_add_u32 v193, v194, 1, v193
    v_lshl_add_u32 v192, v193, 3, v192
    v_add_u32 v173, 65536, v192
    s_lshl_b32 s23, s8, 12
    v_add_u32 v174, s23, v2
    s_lshl_b32 s10, s62, 10
    s_lshl_b32 s23, s17, 8
    s_add_u32 s10, s10, s23
    s_add_u32 s10, s10, 6389760
    v_and_b32 v175, 1, v0
    v_lshlrev_b32 v175, 7, v175
    s_lshl_b32 s11, s62, 16
    s_lshl_b32 s23, s17, 13
    s_add_u32 s11, s11, s23
    s_add_u32 s11, s11, 4259840
    s_lshl_b32 s12, s17, 14
    s_lshl_b32 s23, s17, 3
    v_add_u32 v186, s23, v254
    v_lshlrev_b32 v5, 7, v0
    s_lshl_b32 s23, s17, 1
    s_add_u32 s23, s23, s16
    s_lshl_b32 s28, s23, 10
    s_add_u32 s28, s28, 153600
    v_add_u32 v252, s28, v2
    v_xor_b32 v250, 1024, v252
    s_lshl_b32 s28, s23, 7
    s_add_u32 s28, s28, 161792
    v_lshl_add_u32 v253, v6, 2, s28
    v_xor_b32 v251, 128, v253
    s_waitcnt lgkmcnt(0)
    v_mov_b64 v[124:125], 0
    v_mov_b64 v[126:127], 0
    v_mov_b64 v[128:129], 0
    v_mov_b64 v[130:131], 0
    v_mov_b64 v[136:137], 0
    v_mov_b64 v[138:139], 0
    v_mov_b64 v[140:141], 0
    v_mov_b64 v[142:143], 0
    v_mov_b64 v[148:149], 0
    v_mov_b64 v[150:151], 0
    v_mov_b64 v[152:153], 0
    v_mov_b64 v[154:155], 0
    v_mov_b64 v[160:161], 0
    v_mov_b64 v[162:163], 0
    v_mov_b64 v[164:165], 0
    v_mov_b64 v[166:167], 0
    s_mov_b32 s34, 0x3f803f80
    s_mov_b32 s35, 0x3f803f80
    s_mov_b32 exec_lo, 0x00110000
    s_mov_b32 exec_hi, 0x00110000
    v_mov_b64 v[124:125], s[34:35]
    v_mov_b64 v[126:127], s[34:35]
    v_mov_b64 v[128:129], s[34:35]
    v_mov_b64 v[130:131], s[34:35]
    v_mov_b64 v[136:137], s[34:35]
    v_mov_b64 v[138:139], s[34:35]
    v_mov_b64 v[140:141], s[34:35]
    v_mov_b64 v[142:143], s[34:35]
    v_mov_b64 v[148:149], s[34:35]
    v_mov_b64 v[150:151], s[34:35]
    v_mov_b64 v[152:153], s[34:35]
    v_mov_b64 v[154:155], s[34:35]
    v_mov_b64 v[160:161], s[34:35]
    v_mov_b64 v[162:163], s[34:35]
    v_mov_b64 v[164:165], s[34:35]
    v_mov_b64 v[166:167], s[34:35]
    s_mov_b64 exec, -1
    v_mov_b64 v[48:49], 0
    v_mov_b64 v[50:51], 0
    v_mov_b64 v[52:53], 0
    v_mov_b64 v[54:55], 0
    v_mov_b64 v[56:57], 0
    v_mov_b64 v[58:59], 0
    v_mov_b64 v[60:61], 0
    v_mov_b64 v[62:63], 0
    v_mov_b64 v[64:65], 0
    v_mov_b64 v[66:67], 0
    v_mov_b64 v[68:69], 0
    v_mov_b64 v[70:71], 0
    v_mov_b64 v[72:73], 0
    v_mov_b64 v[74:75], 0
    v_mov_b64 v[76:77], 0
    v_mov_b64 v[78:79], 0
    v_mov_b32 v202, 0xdddd
    v_mov_b64 v[104:105], 0
    v_mov_b64 v[106:107], 0
    v_mov_b64 v[108:109], 0
    v_mov_b64 v[110:111], 0
    s_cmp_lg_u32 s19, 3
    s_cbranch_scc1 H1_WAIT
    s_mov_b32 exec_hi, 0
    s_mov_b32 s94, 0
    s_branch H1_POLL_IN
H1_POLL:
H1_POLL_IN:
    buffer_load_dword v80, v5, s[88:91], s95 offen sc1
    s_add_u32 s94, s94, 1
    s_waitcnt vmcnt(0)
    v_cmp_ne_u32 vcc, s92, v80
    s_cmp_ge_u32 s94, 0x40000
    s_cbranch_scc1 H1_POLL_OUT
    s_cbranch_vccz H1_POLL_OUT
    s_mov_b64 exec, vcc
    s_branch H1_POLL
H1_POLL_OUT:
    s_mov_b64 exec, -1
H1_WAIT:
    s_barrier
    ds_read_b32 v16, v251
    ds_read_b32 v32, v253
    ds_read_b128 v[8:11], v250
    ds_read_b128 v[120:123], v248
    ds_read_b128 v[12:15], v252
    s_mov_b64 exec, s[30:31]
    ds_read_b128 v[124:127], v249 offset:1024
    ds_read_b128 v[128:131], v249 offset:1536
    s_mov_b64 exec, -1
P2_START:
    s_add_u32 s28, s14, 1
    s_lshl_b32 s28, s28, 11
    s_and_b32 s28, s28, 0xffff
    buffer_load_dwordx4 v[132:135], v196, s[88:91], s28 offen sc1
    s_mov_b64 exec, s[30:31]
    buffer_load_dwordx4 v[136:139], v197, s[88:91], s28 offen offset:1024 sc1
    buffer_load_dwordx4 v[140:143], v197, s[88:91], s28 offen offset:1536 sc1
    s_mov_b64 exec, -1
    s_add_u32 s28, s28, 2048
    s_and_b32 s28, s28, 0xffff
    buffer_load_dwordx4 v[144:147], v196, s[88:91], s28 offen sc1
    s_mov_b64 exec, s[30:31]
    buffer_load_dwordx4 v[148:151], v197, s[88:91], s28 offen offset:1024 sc1
    buffer_load_dwordx4 v[152:155], v197, s[88:91], s28 offen offset:1536 sc1
    s_mov_b64 exec, -1
    s_add_u32 s28, s28, 2048
    s_and_b32 s28, s28, 0xffff
    s_mov_b32 s23, 0
    s_waitcnt lgkmcnt(5)
    v_mov_b32 v17, v16
    v_mov_b64 v[18:19], v[16:17]
    v_mov_b64 v[20:21], v[16:17]
    v_mov_b64 v[22:23], v[16:17]
    v_mov_b64 v[24:25], v[16:17]
    v_mov_b64 v[26:27], v[16:17]
    v_mov_b64 v[28:29], v[16:17]
    v_mov_b64 v[30:31], v[16:17]
    s_waitcnt lgkmcnt(3)
    s_nop 0
    v_mfma_f32_32x32x16_bf16 v[80:95], v[120:123], v[8:11], v[16:31]
    v_mov_b32 v33, v32
    v_mov_b64 v[34:35], v[32:33]
    v_mov_b64 v[36:37], v[32:33]
    v_mov_b64 v[38:39], v[32:33]
    v_mov_b64 v[40:41], v[32:33]
    v_mov_b64 v[42:43], v[32:33]
    v_mov_b64 v[44:45], v[32:33]
    v_mov_b64 v[46:47], v[32:33]
    s_waitcnt lgkmcnt(0)
    s_nop 2
    v_exp_f32 v80, v80
    s_setprio 1
    s_cmp_ge_u32 s19, 4
    s_cbranch_scc1 P2_LOOPB
.p2align 6
P2_LOOPA:
    v_exp_f32 v81, v81
    v_smfmac_f32_32x32x32_bf16 v[64:79], v[164:167], v[104:111], v202
    buffer_load_dwordx4 v[156:159], v196, s[88:91], s28 offen sc1
    v_exp_f32 v82, v82
    v_exp_f32 v83, v83
    v_exp_f32 v84, v84
    v_mfma_f32_32x32x16_bf16 v[96:111], v[120:123], v[12:15], v[32:47]
    v_exp_f32 v85, v85
    v_exp_f32 v86, v86
    v_exp_f32 v87, v87
    v_exp_f32 v88, v88
    v_exp_f32 v89, v89
    v_smfmac_f32_32x32x32_bf16 v[48:63], v[124:127], v[80:87], v202
    s_mov_b64 exec, s[30:31]
    buffer_load_dwordx4 v[160:163], v197, s[88:91], s28 offen offset:1024 sc1
    buffer_load_dwordx4 v[164:167], v197, s[88:91], s28 offen offset:1536 sc1
    s_mov_b64 exec, -1
    s_add_u32 s28, s28, 2048
    s_and_b32 s28, s28, 0xffff
    v_exp_f32 v90, v90
    v_exp_f32 v91, v91
    v_exp_f32 v92, v92
    v_exp_f32 v93, v93
    v_exp_f32 v94, v94
    v_exp_f32 v95, v95
    v_exp_f32 v96, v96
    v_exp_f32 v97, v97
    v_smfmac_f32_32x32x32_bf16 v[48:63], v[128:131], v[88:95], v202
    v_exp_f32 v98, v98
    v_exp_f32 v99, v99
    v_exp_f32 v100, v100
    s_waitcnt vmcnt(6)
    s_lshl_b32 s3, s38, 13
    s_add_u32 m0, s3, s37
    s_lshl3_add_u32 s3, s3, s36
    buffer_load_dwordx4 v4, s[40:43], s3 offen lds
    s_add_u32 s38, s38, 1
    s_and_b32 s38, s38, 7
    s_bitcmp1_b32 s32, s23
    s_cbranch_scc1 P2_HOOK
P2_HRET0:
    s_add_u32 s23, s23, 1
    v_mfma_f32_32x32x16_bf16 v[80:95], v[132:135], v[8:11], v[16:31]
    v_exp_f32 v101, v101
    v_exp_f32 v102, v102
    v_exp_f32 v103, v103
    v_exp_f32 v104, v104
    v_exp_f32 v105, v105
    v_smfmac_f32_32x32x32_bf16 v[64:79], v[124:127], v[96:103], v202
    v_exp_f32 v106, v106
    v_exp_f32 v107, v107
    v_exp_f32 v108, v108
    v_exp_f32 v109, v109
    v_exp_f32 v110, v110
    v_exp_f32 v111, v111
    v_exp_f32 v80, v80
    v_exp_f32 v81, v81
    v_smfmac_f32_32x32x32_bf16 v[64:79], v[128:131], v[104:111], v202
    buffer_load_dwordx4 v[120:123], v196, s[88:91], s28 offen sc1
    v_exp_f32 v82, v82
    v_exp_f32 v83, v83
    v_exp_f32 v84, v84
    v_mfma_f32_32x32x16_bf16 v[96:111], v[132:135], v[12:15], v[32:47]
    v_exp_f32 v85, v85
    v_exp_f32 v86, v86
    v_exp_f32 v87, v87
    v_exp_f32 v88, v88
    v_exp_f32 v89, v89
    v_smfmac_f32_32x32x32_bf16 v[48:63], v[136:139], v[80:87], v202
    s_mov_b64 exec, s[30:31]
    buffer_load_dwordx4 v[124:127], v197, s[88:91], s28 offen offset:1024 sc1
    buffer_load_dwordx4 v[128:131], v197, s[88:91], s28 offen offset:1536 sc1
    s_mov_b64 exec, -1
    s_add_u32 s28, s28, 2048
    s_and_b32 s28, s28, 0xffff
    v_exp_f32 v90, v90
    v_exp_f32 v91, v91
    v_exp_f32 v92, v92
    v_exp_f32 v93, v93
    v_exp_f32 v94, v94
    v_exp_f32 v95, v95
    v_exp_f32 v96, v96
    v_exp_f32 v97, v97
    v_smfmac_f32_32x32x32_bf16 v[48:63], v[140:143], v[88:95], v202
    v_exp_f32 v98, v98
    v_exp_f32 v99, v99
    v_exp_f32 v100, v100
    s_waitcnt vmcnt(7)
    v_mfma_f32_32x32x16_bf16 v[80:95], v[144:147], v[8:11], v[16:31]
    v_exp_f32 v101, v101
    v_exp_f32 v102, v102
    v_exp_f32 v103, v103
    v_exp_f32 v104, v104
    v_exp_f32 v105, v105
    v_smfmac_f32_32x32x32_bf16 v[64:79], v[136:139], v[96:103], v202
    v_exp_f32 v106, v106
    v_exp_f32 v107, v107
    v_exp_f32 v108, v108
    v_exp_f32 v109, v109
    v_exp_f32 v110, v110
    v_exp_f32 v111, v111
    v_exp_f32 v80, v80
    v_exp_f32 v81, v81
    v_smfmac_f32_32x32x32_bf16 v[64:79], v[140:143], v[104:111], v202
    buffer_load_dwordx4 v[132:135], v196, s[88:91], s28 offen sc1
    v_exp_f32 v82, v82
    v_exp_f32 v83, v83
    v_exp_f32 v84, v84
    v_mfma_f32_32x32x16_bf16 v[96:111], v[144:147], v[12:15], v[32:47]
    v_exp_f32 v85, v85
    v_exp_f32 v86, v86
    v_exp_f32 v87, v87
    v_exp_f32 v88, v88
    v_exp_f32 v89, v89
    v_smfmac_f32_32x32x32_bf16 v[48:63], v[148:151], v[80:87], v202
    s_mov_b64 exec, s[30:31]
    buffer_load_dwordx4 v[136:139], v197, s[88:91], s28 offen offset:1024 sc1
    buffer_load_dwordx4 v[140:143], v197, s[88:91], s28 offen offset:1536 sc1
    s_mov_b64 exec, -1
    s_add_u32 s28, s28, 2048
    s_and_b32 s28, s28, 0xffff
    v_exp_f32 v90, v90
    v_exp_f32 v91, v91
    v_exp_f32 v92, v92
    v_exp_f32 v93, v93
    v_exp_f32 v94, v94
    v_exp_f32 v95, v95
    v_exp_f32 v96, v96
    v_exp_f32 v97, v97
    v_smfmac_f32_32x32x32_bf16 v[48:63], v[152:155], v[88:95], v202
    v_exp_f32 v98, v98
    v_exp_f32 v99, v99
    v_exp_f32 v100, v100
    s_waitcnt vmcnt(7)
    v_mfma_f32_32x32x16_bf16 v[80:95], v[156:159], v[8:11], v[16:31]
    v_exp_f32 v101, v101
    v_exp_f32 v102, v102
    v_exp_f32 v103, v103
    v_exp_f32 v104, v104
    v_exp_f32 v105, v105
    v_smfmac_f32_32x32x32_bf16 v[64:79], v[148:151], v[96:103], v202
    v_exp_f32 v106, v106
    v_exp_f32 v107, v107
    v_exp_f32 v108, v108
    v_exp_f32 v109, v109
    v_exp_f32 v110, v110
    v_exp_f32 v111, v111
    v_exp_f32 v80, v80
    v_exp_f32 v81, v81
    v_smfmac_f32_32x32x32_bf16 v[64:79], v[152:155], v[104:111], v202
    buffer_load_dwordx4 v[144:147], v196, s[88:91], s28 offen sc1
    v_exp_f32 v82, v82
    v_exp_f32 v83, v83
    v_exp_f32 v84, v84
    v_mfma_f32_32x32x16_bf16 v[96:111], v[156:159], v[12:15], v[32:47]
    v_exp_f32 v85, v85
    v_exp_f32 v86, v86
    v_exp_f32 v87, v87
    v_exp_f32 v88, v88
    v_exp_f32 v89, v89
    v_smfmac_f32_32x32x32_bf16 v[48:63], v[160:163], v[80:87], v202
    s_mov_b64 exec, s[30:31]
    buffer_load_dwordx4 v[148:151], v197, s[88:91], s28 offen offset:1024 sc1
    buffer_load_dwordx4 v[152:155], v197, s[88:91], s28 offen offset:1536 sc1
    s_mov_b64 exec, -1
    s_add_u32 s28, s28, 2048
    s_and_b32 s28, s28, 0xffff
    v_exp_f32 v90, v90
    v_exp_f32 v91, v91
    v_exp_f32 v92, v92
    v_exp_f32 v93, v93
    v_exp_f32 v94, v94
    v_exp_f32 v95, v95
    v_exp_f32 v96, v96
    v_exp_f32 v97, v97
    s_setprio 0
    v_smfmac_f32_32x32x32_bf16 v[48:63], v[164:167], v[88:95], v202
    v_exp_f32 v98, v98
    v_exp_f32 v99, v99
    v_exp_f32 v100, v100
    s_waitcnt vmcnt(6)
    v_mfma_f32_32x32x16_bf16 v[80:95], v[120:123], v[8:11], v[16:31]
    v_exp_f32 v101, v101
    v_exp_f32 v102, v102
    v_exp_f32 v103, v103
    v_exp_f32 v104, v104
    v_exp_f32 v105, v105
    v_smfmac_f32_32x32x32_bf16 v[64:79], v[160:163], v[96:103], v202
    v_exp_f32 v106, v106
    v_exp_f32 v107, v107
    v_exp_f32 v108, v108
    v_exp_f32 v109, v109
    v_exp_f32 v110, v110
    v_exp_f32 v111, v111
    v_exp_f32 v80, v80
    s_setprio 1
    s_cmp_lt_u32 s23, 8
    s_cbranch_scc1 P2_LOOPA
    s_branch P2_DRAIN
.p2align 6
P2_LOOPB:
    v_exp_f32 v81, v81
    v_smfmac_f32_32x32x32_bf16 v[64:79], v[164:167], v[104:111], v202
    buffer_load_dwordx4 v[156:159], v196, s[88:91], s28 offen sc1
    v_exp_f32 v82, v82
    v_exp_f32 v83, v83
    v_exp_f32 v84, v84
    v_mfma_f32_32x32x16_bf16 v[96:111], v[120:123], v[12:15], v[32:47]
    v_exp_f32 v85, v85
    v_exp_f32 v86, v86
    v_exp_f32 v87, v87
    v_exp_f32 v88, v88
    v_exp_f32 v89, v89
    v_smfmac_f32_32x32x32_bf16 v[48:63], v[124:127], v[80:87], v202
    s_mov_b64 exec, s[30:31]
    buffer_load_dwordx4 v[160:163], v197, s[88:91], s28 offen offset:1024 sc1
    buffer_load_dwordx4 v[164:167], v197, s[88:91], s28 offen offset:1536 sc1
    s_mov_b64 exec, -1
    s_add_u32 s28, s28, 2048
    s_and_b32 s28, s28, 0xffff
    v_exp_f32 v90, v90
    v_exp_f32 v91, v91
    v_exp_f32 v92, v92
    v_exp_f32 v93, v93
    v_exp_f32 v94, v94
    v_exp_f32 v95, v95
    v_exp_f32 v96, v96
    v_exp_f32 v97, v97
    v_smfmac_f32_32x32x32_bf16 v[48:63], v[128:131], v[88:95], v202
    v_exp_f32 v98, v98
    v_exp_f32 v99, v99
    v_exp_f32 v100, v100
    s_waitcnt vmcnt(6)
    s_lshl_b32 s3, s38, 13
    s_add_u32 m0, s3, s37
    s_lshl3_add_u32 s3, s3, s36
    buffer_load_dwordx4 v4, s[40:43], s3 offen lds
    s_add_u32 s38, s38, 1
    s_and_b32 s38, s38, 7
    s_add_u32 s23, s23, 1
    v_mfma_f32_32x32x16_bf16 v[80:95], v[132:135], v[8:11], v[16:31]
    v_exp_f32 v101, v101
    v_exp_f32 v102, v102
    v_exp_f32 v103, v103
    v_exp_f32 v104, v104
    v_exp_f32 v105, v105
    v_smfmac_f32_32x32x32_bf16 v[64:79], v[124:127], v[96:103], v202
    v_exp_f32 v106, v106
    v_exp_f32 v107, v107
    v_exp_f32 v108, v108
    v_exp_f32 v109, v109
    v_exp_f32 v110, v110
    v_exp_f32 v111, v111
    v_exp_f32 v80, v80
    v_exp_f32 v81, v81
    v_smfmac_f32_32x32x32_bf16 v[64:79], v[128:131], v[104:111], v202
    buffer_load_dwordx4 v[120:123], v196, s[88:91], s28 offen sc1
    v_exp_f32 v82, v82
    v_exp_f32 v83, v83
    v_exp_f32 v84, v84
    v_mfma_f32_32x32x16_bf16 v[96:111], v[132:135], v[12:15], v[32:47]
    v_exp_f32 v85, v85
    v_exp_f32 v86, v86
    v_exp_f32 v87, v87
    v_exp_f32 v88, v88
    v_exp_f32 v89, v89
    v_smfmac_f32_32x32x32_bf16 v[48:63], v[136:139], v[80:87], v202
    s_mov_b64 exec, s[30:31]
    buffer_load_dwordx4 v[124:127], v197, s[88:91], s28 offen offset:1024 sc1
    buffer_load_dwordx4 v[128:131], v197, s[88:91], s28 offen offset:1536 sc1
    s_mov_b64 exec, -1
    s_add_u32 s28, s28, 2048
    s_and_b32 s28, s28, 0xffff
    v_exp_f32 v90, v90
    v_exp_f32 v91, v91
    v_exp_f32 v92, v92
    v_exp_f32 v93, v93
    v_exp_f32 v94, v94
    v_exp_f32 v95, v95
    v_exp_f32 v96, v96
    v_exp_f32 v97, v97
    v_smfmac_f32_32x32x32_bf16 v[48:63], v[140:143], v[88:95], v202
    v_exp_f32 v98, v98
    v_exp_f32 v99, v99
    v_exp_f32 v100, v100
    s_waitcnt vmcnt(7)
    v_mfma_f32_32x32x16_bf16 v[80:95], v[144:147], v[8:11], v[16:31]
    v_exp_f32 v101, v101
    v_exp_f32 v102, v102
    v_exp_f32 v103, v103
    v_exp_f32 v104, v104
    v_exp_f32 v105, v105
    v_smfmac_f32_32x32x32_bf16 v[64:79], v[136:139], v[96:103], v202
    v_exp_f32 v106, v106
    v_exp_f32 v107, v107
    v_exp_f32 v108, v108
    v_exp_f32 v109, v109
    v_exp_f32 v110, v110
    v_exp_f32 v111, v111
    v_exp_f32 v80, v80
    v_exp_f32 v81, v81
    v_smfmac_f32_32x32x32_bf16 v[64:79], v[140:143], v[104:111], v202
    buffer_load_dwordx4 v[132:135], v196, s[88:91], s28 offen sc1
    v_exp_f32 v82, v82
    v_exp_f32 v83, v83
    v_exp_f32 v84, v84
    v_mfma_f32_32x32x16_bf16 v[96:111], v[144:147], v[12:15], v[32:47]
    v_exp_f32 v85, v85
    v_exp_f32 v86, v86
    v_exp_f32 v87, v87
    v_exp_f32 v88, v88
    v_exp_f32 v89, v89
    v_smfmac_f32_32x32x32_bf16 v[48:63], v[148:151], v[80:87], v202
    s_mov_b64 exec, s[30:31]
    buffer_load_dwordx4 v[136:139], v197, s[88:91], s28 offen offset:1024 sc1
    buffer_load_dwordx4 v[140:143], v197, s[88:91], s28 offen offset:1536 sc1
    s_mov_b64 exec, -1
    s_add_u32 s28, s28, 2048
    s_and_b32 s28, s28, 0xffff
    v_exp_f32 v90, v90
    v_exp_f32 v91, v91
    v_exp_f32 v92, v92
    v_exp_f32 v93, v93
    v_exp_f32 v94, v94
    v_exp_f32 v95, v95
    v_exp_f32 v96, v96
    v_exp_f32 v97, v97
    v_smfmac_f32_32x32x32_bf16 v[48:63], v[152:155], v[88:95], v202
    v_exp_f32 v98, v98
    v_exp_f32 v99, v99
    v_exp_f32 v100, v100
    s_waitcnt vmcnt(7)
    v_mfma_f32_32x32x16_bf16 v[80:95], v[156:159], v[8:11], v[16:31]
    v_exp_f32 v101, v101
    v_exp_f32 v102, v102
    v_exp_f32 v103, v103
    v_exp_f32 v104, v104
    v_exp_f32 v105, v105
    v_smfmac_f32_32x32x32_bf16 v[64:79], v[148:151], v[96:103], v202
    v_exp_f32 v106, v106
    v_exp_f32 v107, v107
    v_exp_f32 v108, v108
    v_exp_f32 v109, v109
    v_exp_f32 v110, v110
    v_exp_f32 v111, v111
    v_exp_f32 v80, v80
    v_exp_f32 v81, v81
    v_smfmac_f32_32x32x32_bf16 v[64:79], v[152:155], v[104:111], v202
    buffer_load_dwordx4 v[144:147], v196, s[88:91], s28 offen sc1
    v_exp_f32 v82, v82
    v_exp_f32 v83, v83
    v_exp_f32 v84, v84
    v_mfma_f32_32x32x16_bf16 v[96:111], v[156:159], v[12:15], v[32:47]
    v_exp_f32 v85, v85
    v_exp_f32 v86, v86
    v_exp_f32 v87, v87
    v_exp_f32 v88, v88
    v_exp_f32 v89, v89
    v_smfmac_f32_32x32x32_bf16 v[48:63], v[160:163], v[80:87], v202
    s_mov_b64 exec, s[30:31]
    buffer_load_dwordx4 v[148:151], v197, s[88:91], s28 offen offset:1024 sc1
    buffer_load_dwordx4 v[152:155], v197, s[88:91], s28 offen offset:1536 sc1
    s_mov_b64 exec, -1
    s_add_u32 s28, s28, 2048
    s_and_b32 s28, s28, 0xffff
    v_exp_f32 v90, v90
    v_exp_f32 v91, v91
    v_exp_f32 v92, v92
    v_exp_f32 v93, v93
    v_exp_f32 v94, v94
    v_exp_f32 v95, v95
    v_exp_f32 v96, v96
    v_exp_f32 v97, v97
    v_smfmac_f32_32x32x32_bf16 v[48:63], v[164:167], v[88:95], v202
    v_exp_f32 v98, v98
    v_exp_f32 v99, v99
    v_exp_f32 v100, v100
    s_waitcnt vmcnt(6)
    v_mfma_f32_32x32x16_bf16 v[80:95], v[120:123], v[8:11], v[16:31]
    v_exp_f32 v101, v101
    v_exp_f32 v102, v102
    v_exp_f32 v103, v103
    v_exp_f32 v104, v104
    v_exp_f32 v105, v105
    v_smfmac_f32_32x32x32_bf16 v[64:79], v[160:163], v[96:103], v202
    v_exp_f32 v106, v106
    v_exp_f32 v107, v107
    v_exp_f32 v108, v108
    v_exp_f32 v109, v109
    v_exp_f32 v110, v110
    v_exp_f32 v111, v111
    v_exp_f32 v80, v80
    s_cmp_lt_u32 s23, 8
    s_cbranch_scc1 P2_LOOPB
P2_DRAIN:
    ds_write_b128 v168, v[48:51]
    ds_write_b32 v169, v56 offset:2048
    v_smfmac_f32_32x32x32_bf16 v[64:79], v[164:167], v[104:111], v202
    ds_write_b128 v168, v[52:55] offset:1024
    s_mov_b32 s28, 0x4f800000
    s_nop 9
    v_max_f32 v80, v56, v72
    v_cmp_u_f32 s[56:57], v56, v72
    v_cmp_lt_f32 vcc, s28, v80
    s_nop 3
    s_or_b64 s[56:57], s[56:57], vcc
    s_cbranch_scc0 P2_NOFLAG
    v_mov_b32 v80, 1
    ds_write_b32 v254, v80 offset:8
P2_NOFLAG:
    s_waitcnt vmcnt(9) lgkmcnt(0)
    s_barrier
    ds_read_b32 v81, v254 offset:8
    ds_read_b32 v56, v171 offset:2048
    ds_read_b128 v[48:51], v170
    ds_read_b128 v[52:55], v170 offset:1024
    s_waitcnt lgkmcnt(2)
    v_readfirstlane_b32 s23, v81
    v_add_f32 v56, v56, v72
    v_rcp_f32 v56, v56
    s_cmp_gt_u32 s23, s29
    s_cbranch_scc1 P2_EXACT
    v_mov_b32 v57, v56
    s_waitcnt lgkmcnt(0)
    v_pk_add_f32 v[48:49], v[48:49], v[64:65]
    v_pk_add_f32 v[50:51], v[50:51], v[66:67]
    v_pk_add_f32 v[52:53], v[52:53], v[68:69]
    v_pk_add_f32 v[54:55], v[54:55], v[70:71]
    v_pk_mul_f32 v[48:49], v[48:49], v[56:57]
    v_pk_mul_f32 v[50:51], v[50:51], v[56:57]
    v_pk_mul_f32 v[52:53], v[52:53], v[56:57]
    v_pk_mul_f32 v[54:55], v[54:55], v[56:57]
    v_cvt_pk_bf16_f32 v64, v48, v49
    v_cvt_pk_bf16_f32 v65, v50, v51
    v_cvt_pk_bf16_f32 v66, v52, v53
    v_cvt_pk_bf16_f32 v67, v54, v55
    buffer_store_dwordx4 v[64:67], v2, s[88:91], s33 offen sc1
    s_and_b32 s21, s93, 0xffff
    s_cmp_lt_u32 s19, 4
    s_cbranch_scc1 P3_MUL
    buffer_load_dword v8, v175, s[88:91], s10 offen sc1
    v_mov_b32 v10, 1
    s_mov_b32 s22, 0
    s_mov_b32 s13, 0
    s_mov_b32 s94, 0
    s_waitcnt vmcnt(0)
    v_mov_b32 v12, 1
    s_mov_b64 exec, 1
    ds_add_rtn_u32 v12, v254, v12 offset:16
    s_waitcnt lgkmcnt(0)
    v_readfirstlane_b32 s97, v12
    v_mov_b32 v12, s92
    s_nop 1
    s_cmp_lg_u32 s97, 7
    s_cbranch_scc1 P3_FLB
    buffer_store_dword v12, off, s[88:91], s98 sc1
P3_FLB:
    s_mov_b64 exec, -1
P3_HL:
    v_cmp_eq_u32 vcc, s92, v8
    s_add_u32 s94, s94, 1
    s_cmp_ge_u32 s94, 0x40000
    s_cselect_b32 s23, 3, vcc_lo
    s_and_b32 s23, s23, 3
    s_andn2_b32 s23, s23, s22
    s_or_b32 s22, s22, s23
    s_cmp_eq_u32 s22, 3
    s_cbranch_scc1 P3_HN
    buffer_load_dword v8, v175, s[88:91], s10 offen sc1
P3_HN:
    s_bitcmp1_b32 s23, 0
    s_cbranch_scc0 P3_HS0
    s_add_u32 m0, s12, 0
    s_add_u32 s3, s11, 0
    buffer_load_dwordx4 v2, s[88:91], s3 offen offset:0 sc1 lds
    buffer_load_dwordx4 v2, s[88:91], s3 offen offset:1024 sc1 lds
    buffer_load_dwordx4 v2, s[88:91], s3 offen offset:2048 sc1 lds
    buffer_load_dwordx4 v2, s[88:91], s3 offen offset:3072 sc1 lds
    s_add_u32 m0, s12, 4096
    s_add_u32 s3, s11, 32768
    buffer_load_dwordx4 v2, s[88:91], s3 offen offset:0 sc1 lds
    buffer_load_dwordx4 v2, s[88:91], s3 offen offset:1024 sc1 lds
    buffer_load_dwordx4 v2, s[88:91], s3 offen offset:2048 sc1 lds
    buffer_load_dwordx4 v2, s[88:91], s3 offen offset:3072 sc1 lds
P3_HS0:
    s_bitcmp1_b32 s23, 1
    s_cbranch_scc0 P3_HS1
    s_add_u32 m0, s12, 8192
    s_add_u32 s3, s11, 4096
    buffer_load_dwordx4 v2, s[88:91], s3 offen offset:0 sc1 lds
    buffer_load_dwordx4 v2, s[88:91], s3 offen offset:1024 sc1 lds
    buffer_load_dwordx4 v2, s[88:91], s3 offen offset:2048 sc1 lds
    buffer_load_dwordx4 v2, s[88:91], s3 offen offset:3072 sc1 lds
    s_add_u32 m0, s12, 12288
    s_add_u32 s3, s11, 36864
    buffer_load_dwordx4 v2, s[88:91], s3 offen offset:0 sc1 lds
    buffer_load_dwordx4 v2, s[88:91], s3 offen offset:1024 sc1 lds
    buffer_load_dwordx4 v2, s[88:91], s3 offen offset:2048 sc1 lds
    buffer_load_dwordx4 v2, s[88:91], s3 offen offset:3072 sc1 lds
P3_HS1:
    s_cmp_eq_u32 s22, 3
    s_cbranch_scc1 P3_HE
    s_cmp_eq_u32 s23, 0
    s_cbranch_scc1 P3_HW
    s_waitcnt vmcnt(8)
    s_branch P3_HL
P3_HW:
    s_waitcnt vmcnt(0)
    s_cmp_eq_u32 s13, s22
    s_cbranch_scc1 P3_HL
    s_mov_b32 s13, s22
    s_lshr_b32 s3, s22, 1
    s_lshl_b32 s3, s3, 2
    v_add_u32 v9, s3, v186
    ds_write_b32 v9, v10 offset:32
    s_branch P3_HL
P3_HE:
    s_cmp_eq_u32 s23, 1
    s_cselect_b32 s3, 4, 0
    v_add_u32 v9, s3, v186
    s_waitcnt vmcnt(8)
    ds_write_b32 v9, v10 offset:32
    s_waitcnt vmcnt(0)
    ds_write_b32 v186, v10 offset:32
    ds_write_b32 v186, v10 offset:36
    s_endpgm
P3_MUL:
    s_sub_u32 s21, 0xffff, s21
    s_lshr_b32 s20, s21, 5
    ds_read_b64_tr_b16 v[190:191], v173 offset:0
    ds_read_b64_tr_b16 v[192:193], v173 offset:1024
    ds_read_b64_tr_b16 v[194:195], v173 offset:2048
    ds_read_b64_tr_b16 v[196:197], v173 offset:3072
    ds_read_b64_tr_b16 v[198:199], v173 offset:4096
    ds_read_b64_tr_b16 v[200:201], v173 offset:5120
    ds_read_b64_tr_b16 v[202:203], v173 offset:6144
    ds_read_b64_tr_b16 v[204:205], v173 offset:7168
    ds_read_b64_tr_b16 v[206:207], v173 offset:8192
    ds_read_b64_tr_b16 v[208:209], v173 offset:9216
    ds_read_b64_tr_b16 v[210:211], v173 offset:10240
    ds_read_b64_tr_b16 v[212:213], v173 offset:11264
    ds_read_b64_tr_b16 v[214:215], v173 offset:12288
    ds_read_b64_tr_b16 v[216:217], v173 offset:13312
    ds_read_b64_tr_b16 v[218:219], v173 offset:14336
    ds_read_b64_tr_b16 v[220:221], v173 offset:15360
    ds_read_b64_tr_b16 v[222:223], v173 offset:16384
    ds_read_b64_tr_b16 v[224:225], v173 offset:17408
    ds_read_b64_tr_b16 v[226:227], v173 offset:18432
    ds_read_b64_tr_b16 v[228:229], v173 offset:19456
    ds_read_b64_tr_b16 v[230:231], v173 offset:20480
    ds_read_b64_tr_b16 v[232:233], v173 offset:21504
    ds_read_b64_tr_b16 v[234:235], v173 offset:22528
    ds_read_b64_tr_b16 v[236:237], v173 offset:23552
    ds_read_b64_tr_b16 v[238:239], v173 offset:24576
    ds_read_b64_tr_b16 v[240:241], v173 offset:25600
    ds_read_b64_tr_b16 v[242:243], v173 offset:26624
    ds_read_b64_tr_b16 v[244:245], v173 offset:27648
    ds_read_b64_tr_b16 v[246:247], v173 offset:28672
    ds_read_b64_tr_b16 v[248:249], v173 offset:29696
    ds_read_b64_tr_b16 v[250:251], v173 offset:30720
    ds_read_b64_tr_b16 v[252:253], v173 offset:31744
    ds_read_b64_tr_b16 v[104:105], v173 offset:57344
    ds_read_b64_tr_b16 v[106:107], v173 offset:58368
    ds_read_b64_tr_b16 v[108:109], v173 offset:59392
    ds_read_b64_tr_b16 v[110:111], v173 offset:60416
    ds_read_b64_tr_b16 v[112:113], v173 offset:61440
    ds_read_b64_tr_b16 v[114:115], v173 offset:62464
    ds_read_b64_tr_b16 v[116:117], v173 offset:63488
    ds_read_b64_tr_b16 v[118:119], v173 offset:64512
    s_mov_b32 s44, s82
    s_and_b32 s45, s83, 0xffff
    s_mov_b32 s46, 0x200000
    s_mov_b32 s47, 0x00020000
    v_lshlrev_b32 v80, 16, v176
    v_and_b32 v81, 0xffff0000, v176
    v_lshlrev_b32 v82, 16, v177
    v_and_b32 v83, 0xffff0000, v177
    v_lshlrev_b32 v84, 16, v178
    v_and_b32 v85, 0xffff0000, v178
    v_lshlrev_b32 v86, 16, v179
    v_and_b32 v87, 0xffff0000, v179
    v_lshlrev_b32 v88, 16, v180
    v_and_b32 v89, 0xffff0000, v180
    v_lshlrev_b32 v90, 16, v181
    v_and_b32 v91, 0xffff0000, v181
    v_lshlrev_b32 v92, 16, v182
    v_and_b32 v93, 0xffff0000, v182
    v_lshlrev_b32 v94, 16, v183
    v_and_b32 v95, 0xffff0000, v183
    v_mov_b64 v[16:17], 0
    v_mov_b64 v[18:19], 0
    v_mov_b64 v[20:21], 0
    v_mov_b64 v[22:23], 0
    v_mov_b64 v[24:25], 0
    v_mov_b64 v[26:27], 0
    v_mov_b64 v[28:29], 0
    v_mov_b64 v[30:31], 0
    v_and_b32 v5, 7, v0
    v_lshl_add_u32 v5, v5, 2, v254
    s_waitcnt vmcnt(0)
    v_mov_b32 v8, 1
    s_mov_b64 exec, 1
    ds_add_rtn_u32 v8, v254, v8 offset:16
    s_waitcnt lgkmcnt(0)
    v_readfirstlane_b32 s97, v8
    v_mov_b32 v8, s92
    s_nop 1
    s_cmp_lg_u32 s97, 7
    s_cbranch_scc1 P3_FLA
    buffer_store_dword v8, off, s[88:91], s98 sc1
P3_FLA:
    s_mov_b64 exec, -1
    ds_read_b64_tr_b16 v[120:121], v173 offset:32768
    ds_read_b64_tr_b16 v[122:123], v173 offset:33792
    ds_read_b64_tr_b16 v[124:125], v173 offset:34816
    ds_read_b64_tr_b16 v[126:127], v173 offset:35840
    ds_read_b64_tr_b16 v[128:129], v173 offset:36864
    ds_read_b64_tr_b16 v[130:131], v173 offset:37888
    ds_read_b64_tr_b16 v[132:133], v173 offset:38912
    ds_read_b64_tr_b16 v[134:135], v173 offset:39936
    ds_read_b64_tr_b16 v[136:137], v173 offset:40960
    ds_read_b64_tr_b16 v[138:139], v173 offset:41984
    ds_read_b64_tr_b16 v[140:141], v173 offset:43008
    ds_read_b64_tr_b16 v[142:143], v173 offset:44032
    ds_read_b64_tr_b16 v[144:145], v173 offset:45056
    ds_read_b64_tr_b16 v[146:147], v173 offset:46080
    ds_read_b64_tr_b16 v[148:149], v173 offset:47104
    ds_read_b64_tr_b16 v[150:151], v173 offset:48128
    ds_read_b64_tr_b16 v[152:153], v173 offset:49152
    ds_read_b64_tr_b16 v[154:155], v173 offset:50176
    ds_read_b64_tr_b16 v[156:157], v173 offset:51200
    ds_read_b64_tr_b16 v[158:159], v173 offset:52224
    ds_read_b64_tr_b16 v[160:161], v173 offset:53248
    ds_read_b64_tr_b16 v[162:163], v173 offset:54272
    ds_read_b64_tr_b16 v[164:165], v173 offset:55296
    ds_read_b64_tr_b16 v[166:167], v173 offset:56320
    s_cmp_eq_u32 s20, s4
    s_cbranch_scc1 P3_YJOB
P3_YD:
    v_mul_f32 v80, v80, v185
    v_mul_f32 v81, v81, v185
    v_mul_f32 v82, v82, v185
    v_mul_f32 v83, v83, v185
    v_mul_f32 v84, v84, v185
    v_mul_f32 v85, v85, v185
    v_mul_f32 v86, v86, v185
    v_mul_f32 v87, v87, v185
    v_mul_f32 v88, v88, v185
    v_mul_f32 v89, v89, v185
    v_mul_f32 v90, v90, v185
    v_mul_f32 v91, v91, v185
    v_mul_f32 v92, v92, v185
    v_mul_f32 v93, v93, v185
    v_mul_f32 v94, v94, v185
    v_mul_f32 v95, v95, v185
    s_mov_b32 s22, 0
    s_mov_b32 s94, 0
P3_ROUND:
    ds_read_b32 v8, v5 offset:32
    s_add_u32 s94, s94, 1
    s_waitcnt lgkmcnt(0)
    v_cmp_ne_u32 vcc, 0, v8
    s_cmp_ge_u32 s94, 0x2000000
    s_cbranch_scc1 P3_FIN
    s_and_b32 s23, vcc_lo, 0xff
    s_add_u32 s3, s23, 1
    s_xor_b32 s23, s23, s3
    s_lshr_b32 s23, s23, 1
    s_andn2_b32 s23, s23, s22
    s_cbranch_scc0 P3_ROUND
    s_bitcmp1_b32 s23, 0
    s_cbranch_scc0 P3_SK0
    ds_read_b128 v[32:35], v174 offset:0
    ds_read_b128 v[36:39], v174 offset:1024
    ds_read_b128 v[40:43], v174 offset:2048
    ds_read_b128 v[44:47], v174 offset:3072
P3_HV0:
    ds_read_b128 v[48:51], v174 offset:8192
    ds_read_b128 v[52:55], v174 offset:9216
    ds_read_b128 v[56:59], v174 offset:10240
    ds_read_b128 v[60:63], v174 offset:11264
    s_waitcnt lgkmcnt(7)
    v_mfma_f32_32x32x16_bf16 v[16:31], v[190:193], v[32:35], v[16:31]
    s_waitcnt lgkmcnt(6)
    v_mfma_f32_32x32x16_bf16 v[16:31], v[194:197], v[36:39], v[16:31]
    s_waitcnt lgkmcnt(5)
    v_mfma_f32_32x32x16_bf16 v[16:31], v[198:201], v[40:43], v[16:31]
    s_waitcnt lgkmcnt(4)
    v_mfma_f32_32x32x16_bf16 v[16:31], v[202:205], v[44:47], v[16:31]
P3_SK0:
    s_bitcmp1_b32 s23, 1
    s_cbranch_scc0 P3_SK1
    s_bitcmp1_b32 s23, 0
    s_cbranch_scc1 P3_HV1
    ds_read_b128 v[48:51], v174 offset:8192
    ds_read_b128 v[52:55], v174 offset:9216
    ds_read_b128 v[56:59], v174 offset:10240
    ds_read_b128 v[60:63], v174 offset:11264
P3_HV1:
    ds_read_b128 v[32:35], v174 offset:16384
    ds_read_b128 v[36:39], v174 offset:17408
    ds_read_b128 v[40:43], v174 offset:18432
    ds_read_b128 v[44:47], v174 offset:19456
    s_waitcnt lgkmcnt(7)
    v_mfma_f32_32x32x16_bf16 v[16:31], v[206:209], v[48:51], v[16:31]
    s_waitcnt lgkmcnt(6)
    v_mfma_f32_32x32x16_bf16 v[16:31], v[210:213], v[52:55], v[16:31]
    s_waitcnt lgkmcnt(5)
    v_mfma_f32_32x32x16_bf16 v[16:31], v[214:217], v[56:59], v[16:31]
    s_waitcnt lgkmcnt(4)
    v_mfma_f32_32x32x16_bf16 v[16:31], v[218:221], v[60:63], v[16:31]
P3_SK1:
    s_bitcmp1_b32 s23, 2
    s_cbranch_scc0 P3_SK2
    s_bitcmp1_b32 s23, 1
    s_cbranch_scc1 P3_HV2
    ds_read_b128 v[32:35], v174 offset:16384
    ds_read_b128 v[36:39], v174 offset:17408
    ds_read_b128 v[40:43], v174 offset:18432
    ds_read_b128 v[44:47], v174 offset:19456
P3_HV2:
    ds_read_b128 v[48:51], v174 offset:24576
    ds_read_b128 v[52:55], v174 offset:25600
    ds_read_b128 v[56:59], v174 offset:26624
    ds_read_b128 v[60:63], v174 offset:27648
    s_waitcnt lgkmcnt(7)
    v_mfma_f32_32x32x16_bf16 v[16:31], v[222:225], v[32:35], v[16:31]
    s_waitcnt lgkmcnt(6)
    v_mfma_f32_32x32x16_bf16 v[16:31], v[226:229], v[36:39], v[16:31]
    s_waitcnt lgkmcnt(5)
    v_mfma_f32_32x32x16_bf16 v[16:31], v[230:233], v[40:43], v[16:31]
    s_waitcnt lgkmcnt(4)
    v_mfma_f32_32x32x16_bf16 v[16:31], v[234:237], v[44:47], v[16:31]
P3_SK2:
    s_bitcmp1_b32 s23, 3
    s_cbranch_scc0 P3_SK3
    s_bitcmp1_b32 s23, 2
    s_cbranch_scc1 P3_HV3
    ds_read_b128 v[48:51], v174 offset:24576
    ds_read_b128 v[52:55], v174 offset:25600
    ds_read_b128 v[56:59], v174 offset:26624
    ds_read_b128 v[60:63], v174 offset:27648
P3_HV3:
    ds_read_b128 v[32:35], v174 offset:32768
    ds_read_b128 v[36:39], v174 offset:33792
    ds_read_b128 v[40:43], v174 offset:34816
    ds_read_b128 v[44:47], v174 offset:35840
    s_waitcnt lgkmcnt(7)
    v_mfma_f32_32x32x16_bf16 v[16:31], v[238:241], v[48:51], v[16:31]
    s_waitcnt lgkmcnt(6)
    v_mfma_f32_32x32x16_bf16 v[16:31], v[242:245], v[52:55], v[16:31]
    s_waitcnt lgkmcnt(5)
    v_mfma_f32_32x32x16_bf16 v[16:31], v[246:249], v[56:59], v[16:31]
    s_waitcnt lgkmcnt(4)
    v_mfma_f32_32x32x16_bf16 v[16:31], v[250:253], v[60:63], v[16:31]
P3_SK3:
    s_bitcmp1_b32 s23, 4
    s_cbranch_scc0 P3_SK4
    s_bitcmp1_b32 s23, 3
    s_cbranch_scc1 P3_HV4
    ds_read_b128 v[32:35], v174 offset:32768
    ds_read_b128 v[36:39], v174 offset:33792
    ds_read_b128 v[40:43], v174 offset:34816
    ds_read_b128 v[44:47], v174 offset:35840
P3_HV4:
    ds_read_b128 v[48:51], v174 offset:40960
    ds_read_b128 v[52:55], v174 offset:41984
    ds_read_b128 v[56:59], v174 offset:43008
    ds_read_b128 v[60:63], v174 offset:44032
    s_waitcnt lgkmcnt(7)
    v_mfma_f32_32x32x16_bf16 v[16:31], v[120:123], v[32:35], v[16:31]
    s_waitcnt lgkmcnt(6)
    v_mfma_f32_32x32x16_bf16 v[16:31], v[124:127], v[36:39], v[16:31]
    s_waitcnt lgkmcnt(5)
    v_mfma_f32_32x32x16_bf16 v[16:31], v[128:131], v[40:43], v[16:31]
    s_waitcnt lgkmcnt(4)
    v_mfma_f32_32x32x16_bf16 v[16:31], v[132:135], v[44:47], v[16:31]
P3_SK4:
    s_bitcmp1_b32 s23, 5
    s_cbranch_scc0 P3_SK5
    s_bitcmp1_b32 s23, 4
    s_cbranch_scc1 P3_HV5
    ds_read_b128 v[48:51], v174 offset:40960
    ds_read_b128 v[52:55], v174 offset:41984
    ds_read_b128 v[56:59], v174 offset:43008
    ds_read_b128 v[60:63], v174 offset:44032
P3_HV5:
    ds_read_b128 v[32:35], v174 offset:49152
    ds_read_b128 v[36:39], v174 offset:50176
    ds_read_b128 v[40:43], v174 offset:51200
    ds_read_b128 v[44:47], v174 offset:52224
    s_waitcnt lgkmcnt(7)
    v_mfma_f32_32x32x16_bf16 v[16:31], v[136:139], v[48:51], v[16:31]
    s_waitcnt lgkmcnt(6)
    v_mfma_f32_32x32x16_bf16 v[16:31], v[140:143], v[52:55], v[16:31]
    s_waitcnt lgkmcnt(5)
    v_mfma_f32_32x32x16_bf16 v[16:31], v[144:147], v[56:59], v[16:31]
    s_waitcnt lgkmcnt(4)
    v_mfma_f32_32x32x16_bf16 v[16:31], v[148:151], v[60:63], v[16:31]
P3_SK5:
    s_bitcmp1_b32 s23, 6
    s_cbranch_scc0 P3_SK6
    s_bitcmp1_b32 s23, 5
    s_cbranch_scc1 P3_HV6
    ds_read_b128 v[32:35], v174 offset:49152
    ds_read_b128 v[36:39], v174 offset:50176
    ds_read_b128 v[40:43], v174 offset:51200
    ds_read_b128 v[44:47], v174 offset:52224
P3_HV6:
    ds_read_b128 v[48:51], v174 offset:57344
    ds_read_b128 v[52:55], v174 offset:58368
    ds_read_b128 v[56:59], v174 offset:59392
    ds_read_b128 v[60:63], v174 offset:60416
    s_waitcnt lgkmcnt(7)
    v_mfma_f32_32x32x16_bf16 v[16:31], v[152:155], v[32:35], v[16:31]
    s_waitcnt lgkmcnt(6)
    v_mfma_f32_32x32x16_bf16 v[16:31], v[156:159], v[36:39], v[16:31]
    s_waitcnt lgkmcnt(5)
    v_mfma_f32_32x32x16_bf16 v[16:31], v[160:163], v[40:43], v[16:31]
    s_waitcnt lgkmcnt(4)
    v_mfma_f32_32x32x16_bf16 v[16:31], v[164:167], v[44:47], v[16:31]
P3_SK6:
    s_bitcmp1_b32 s23, 7
    s_cbranch_scc0 P3_SK7
    s_bitcmp1_b32 s23, 6
    s_cbranch_scc1 P3_HV7
    ds_read_b128 v[48:51], v174 offset:57344
    ds_read_b128 v[52:55], v174 offset:58368
    ds_read_b128 v[56:59], v174 offset:59392
    ds_read_b128 v[60:63], v174 offset:60416
P3_HV7:
    s_waitcnt lgkmcnt(3)
    v_mfma_f32_32x32x16_bf16 v[16:31], v[104:107], v[48:51], v[16:31]
    s_waitcnt lgkmcnt(2)
    v_mfma_f32_32x32x16_bf16 v[16:31], v[108:111], v[52:55], v[16:31]
    s_waitcnt lgkmcnt(1)
    v_mfma_f32_32x32x16_bf16 v[16:31], v[112:115], v[56:59], v[16:31]
    s_waitcnt lgkmcnt(0)
    v_mfma_f32_32x32x16_bf16 v[16:31], v[116:119], v[60:63], v[16:31]
P3_SK7:
    s_or_b32 s22, s22, s23
    s_cmp_lg_u32 s22, 0xff
    s_cbranch_scc1 P3_ROUND
P3_FIN:
    s_nop 10
    v_fma_f32 v80, v16, v184, v80
    v_fma_f32 v81, v17, v184, v81
    v_cvt_pk_bf16_f32 v176, v80, v81
    v_fma_f32 v82, v18, v184, v82
    v_fma_f32 v83, v19, v184, v83
    v_cvt_pk_bf16_f32 v177, v82, v83
    v_fma_f32 v84, v20, v184, v84
    v_fma_f32 v85, v21, v184, v85
    v_cvt_pk_bf16_f32 v178, v84, v85
    v_fma_f32 v86, v22, v184, v86
    v_fma_f32 v87, v23, v184, v87
    v_cvt_pk_bf16_f32 v179, v86, v87
    v_fma_f32 v88, v24, v184, v88
    buffer_store_dwordx4 v[176:179], v172, s[44:47], s6 offen
    v_fma_f32 v89, v25, v184, v89
    v_cvt_pk_bf16_f32 v180, v88, v89
    v_fma_f32 v90, v26, v184, v90
    v_fma_f32 v91, v27, v184, v91
    v_cvt_pk_bf16_f32 v181, v90, v91
    v_fma_f32 v92, v28, v184, v92
    v_fma_f32 v93, v29, v184, v93
    v_cvt_pk_bf16_f32 v182, v92, v93
    v_fma_f32 v94, v30, v184, v94
    v_fma_f32 v95, v31, v184, v95
    v_cvt_pk_bf16_f32 v183, v94, v95
    buffer_store_dwordx4 v[180:183], v172, s[44:47], s6 offen offset:16
L_END:
    s_endpgm
P3_YJOB:
    s_mov_b32 s94, 0
P3_ALL:
    v_xor_b32 v186, s92, v186
    v_xor_b32 v187, s92, v187
    v_xor_b32 v188, s92, v188
    v_xor_b32 v189, s92, v189
    v_or3_b32 v186, v186, v187, v188
    v_or_b32 v186, v186, v189
    v_cmp_ne_u32 vcc, 0, v186
    s_add_u32 s94, s94, 1
    s_cmp_ge_u32 s94, 0x40000
    s_cbranch_scc1 P3_ALLD
    s_cbranch_vccz P3_ALLD
    v_lshlrev_b32 v13, 7, v0
    s_mov_b32 s3, 6422528
    buffer_load_dword v186, v13, s[88:91], s3 offen sc1
    s_mov_b32 s3, 6430720
    buffer_load_dword v187, v13, s[88:91], s3 offen sc1
    s_mov_b32 s3, 6438912
    buffer_load_dword v188, v13, s[88:91], s3 offen sc1
    s_mov_b32 s3, 6447104
    buffer_load_dword v189, v13, s[88:91], s3 offen sc1
    s_waitcnt vmcnt(0)
    s_branch P3_ALL
P3_ALLD:
    v_lshrrev_b32 v12, 2, v0
    v_and_b32 v13, 3, v0
    v_lshlrev_b32 v14, 7, v12
    v_lshl_add_u32 v14, v13, 4, v14
    v_lshlrev_b32 v12, 11, v12
    v_lshl_add_u32 v12, v13, 4, v12
    s_lshr_b32 s30, s5, 8
    s_lshl_b32 s30, s30, 9
    s_and_b32 s31, s5, 255
    s_add_u32 s30, s30, s31
    s_add_u32 s30, s30, 6743040
    buffer_load_dwordx4 v[96:99], v12, s[88:91], s30 offen sc1
    buffer_load_dwordx4 v[100:103], v12, s[88:91], s30 offen offset:256 sc1
    s_mul_i32 s30, s19, 2304
    s_add_u32 s30, s30, 153600
    v_add_u32 v14, s30, v14
    s_waitcnt vmcnt(0)
    ds_write_b128 v14, v[96:99]
    ds_write_b128 v14, v[100:103] offset:64
    v_lshlrev_b32 v14, 10, v7
    v_lshl_add_u32 v14, v6, 2, v14
    v_add_u32 v14, s30, v14
    s_waitcnt lgkmcnt(0)
    ds_read_b32 v96, v14 offset:0
    ds_read_b32 v97, v14 offset:128
    ds_read_b32 v98, v14 offset:256
    ds_read_b32 v99, v14 offset:384
    ds_read_b32 v100, v14 offset:512
    ds_read_b32 v101, v14 offset:640
    ds_read_b32 v102, v14 offset:768
    ds_read_b32 v103, v14 offset:896
    s_and_b32 s31, s93, 0xffff0000
    s_ashr_i32 s28, s31, 31
    s_not_b32 s28, s28
    s_or_b32 s28, s28, 0x80000000
    s_xor_b32 s31, s31, s28
    s_and_b32 s31, s31, 0xffff0000
    v_mov_b32 v15, s31
    v_mul_f32 v15, 0xbfb8aa3b, v15
    v_exp_f32 v15, v15
    s_nop 0
    v_add_f32 v15, 1.0, v15
    v_rcp_f32 v15, v15
    s_nop 0
    v_cvt_pk_bf16_f32 v15, v15, v15
    v_lshlrev_b32 v15, 16, v15
    s_waitcnt lgkmcnt(0)
    v_add_f32 v96, v96, v97
    v_add_f32 v96, v96, v98
    v_add_f32 v96, v96, v99
    v_add_f32 v96, v96, v100
    v_add_f32 v96, v96, v101
    v_add_f32 v96, v96, v102
    v_add_f32 v96, v96, v103
    v_mov_b32 v97, v96
    v_and_b32 v14, 15, v0
    v_lshlrev_b32 v14, 3, v14
    v_permlane32_swap_b32 v96, v97
    v_add_f32 v96, v96, v97
    v_cvt_pk_bf16_f32 v96, v96, v96
    v_lshlrev_b32 v96, 16, v96
    v_mul_f32 v96, v96, v15
    v_cvt_pk_bf16_f32 v96, v96, v96
    v_lshlrev_b32 v96, 16, v96
    v_bfe_u32 v15, v0, 4, 1
    v_lshl_add_u32 v14, v15, 2, v14
    v_add_u32 v14, s30, v14
    ds_write_b32 v14, v96 offset:2048
    v_lshl_add_u32 v14, v7, 6, s30
    ds_read_b128 v[32:35], v14 offset:2048
    ds_read_b128 v[36:39], v14 offset:2064
    ds_read_b128 v[40:43], v14 offset:2080
    ds_read_b128 v[44:47], v14 offset:2096
    s_and_b32 s30, s21, 31
    v_cmp_eq_u32 vcc, s30, v6
    s_waitcnt lgkmcnt(0)
    s_and_saveexec_b64 s[48:49], vcc
    v_add_f32 v80, v80, v32
    v_cvt_pk_bf16_f32 v80, v80, v80
    v_lshlrev_b32 v80, 16, v80
    v_add_f32 v81, v81, v33
    v_cvt_pk_bf16_f32 v81, v81, v81
    v_lshlrev_b32 v81, 16, v81
    v_add_f32 v82, v82, v34
    v_cvt_pk_bf16_f32 v82, v82, v82
    v_lshlrev_b32 v82, 16, v82
    v_add_f32 v83, v83, v35
    v_cvt_pk_bf16_f32 v83, v83, v83
    v_lshlrev_b32 v83, 16, v83
    v_add_f32 v84, v84, v36
    v_cvt_pk_bf16_f32 v84, v84, v84
    v_lshlrev_b32 v84, 16, v84
    v_add_f32 v85, v85, v37
    v_cvt_pk_bf16_f32 v85, v85, v85
    v_lshlrev_b32 v85, 16, v85
    v_add_f32 v86, v86, v38
    v_cvt_pk_bf16_f32 v86, v86, v86
    v_lshlrev_b32 v86, 16, v86
    v_add_f32 v87, v87, v39
    v_cvt_pk_bf16_f32 v87, v87, v87
    v_lshlrev_b32 v87, 16, v87
    v_add_f32 v88, v88, v40
    v_cvt_pk_bf16_f32 v88, v88, v88
    v_lshlrev_b32 v88, 16, v88
    v_add_f32 v89, v89, v41
    v_cvt_pk_bf16_f32 v89, v89, v89
    v_lshlrev_b32 v89, 16, v89
    v_add_f32 v90, v90, v42
    v_cvt_pk_bf16_f32 v90, v90, v90
    v_lshlrev_b32 v90, 16, v90
    v_add_f32 v91, v91, v43
    v_cvt_pk_bf16_f32 v91, v91, v91
    v_lshlrev_b32 v91, 16, v91
    v_add_f32 v92, v92, v44
    v_cvt_pk_bf16_f32 v92, v92, v92
    v_lshlrev_b32 v92, 16, v92
    v_add_f32 v93, v93, v45
    v_cvt_pk_bf16_f32 v93, v93, v93
    v_lshlrev_b32 v93, 16, v93
    v_add_f32 v94, v94, v46
    v_cvt_pk_bf16_f32 v94, v94, v94
    v_lshlrev_b32 v94, 16, v94
    v_add_f32 v95, v95, v47
    v_cvt_pk_bf16_f32 v95, v95, v95
    v_lshlrev_b32 v95, 16, v95
    s_mov_b64 exec, s[48:49]
    s_branch P3_YD
P2_PAD0:
P2_HRET:
    s_branch P2_HRET0
P2_HOOK:
    s_cmp_eq_u32 s23, 0
    s_cbranch_scc1 P2_J0
    s_cmp_eq_u32 s23, 1
    s_cbranch_scc1 P2_J1
    s_cmp_eq_u32 s23, 2
    s_cbranch_scc1 P2_J2
    s_cmp_eq_u32 s23, 3
    s_cbranch_scc1 P2_J3
    s_cmp_eq_u32 s23, 4
    s_cbranch_scc1 P2_J4
    s_cmp_eq_u32 s23, 5
    s_cbranch_scc1 P2_J5
    s_cmp_eq_u32 s23, 6
    s_cbranch_scc1 P2_J6
    s_cmp_eq_u32 s23, 7
    s_cbranch_scc1 P2_J7
    s_branch P2_PAD0
P2_J0:
    s_cmp_eq_u32 s39, -1
    s_cbranch_scc1 P2_NOKEY
    s_lshl_b32 s3, s39, 3
    s_add_u32 s3, s3, 6455296
    v_mov_b32 v240, s93
    v_mov_b32 v241, s92
    s_waitcnt vmcnt(0)
    s_mov_b64 exec, 1
    buffer_store_dwordx2 v[240:241], off, s[88:91], s3 sc1
    s_mov_b64 exec, -1
P2_NOKEY:
    s_branch P2_PAD0
P2_J1:
    v_lshlrev_b32 v5, 3, v0
    s_mov_b32 s3, 6455296
    buffer_load_dwordx2 v[240:241], v5, s[88:91], s3 offen sc1
    s_cmp_ge_u32 s2, 224
    s_cbranch_scc1 P2_PAD0
    s_cmp_lt_u32 s19, 2
    s_cselect_b32 s44, s74, s76
    s_cselect_b32 s45, s75, s77
    s_and_b32 s52, s2, 7
    s_mul_i32 s52, s52, 229376
    s_lshr_b32 s53, s2, 3
    s_lshl_b32 s53, s53, 7
    s_add_u32 s52, s52, s53
    s_and_b32 s45, s45, 0xffff
    s_mov_b32 s46, 0x1c0000
    s_mov_b32 s47, 0x00020000
    v_lshrrev_b32 v5, 2, v0
    v_mul_u32_u24 v5, 3584, v5
    v_and_b32 v252, 3, v0
    v_lshl_add_u32 v5, v252, 4, v5
    s_and_b32 s53, s19, 1
    s_lshl_b32 s53, s53, 6
    s_add_u32 s52, s52, s53
    s_lshl_b32 s54, s19, 12
    s_add_u32 m0, s54, 32768
    s_add_u32 s53, s52, 0
    buffer_load_dwordx4 v5, s[44:47], s53 offen lds
    s_add_u32 m0, s54, 33792
    s_add_u32 s53, s52, 57344
    buffer_load_dwordx4 v5, s[44:47], s53 offen lds
    s_branch P2_PAD0
P2_J2:
    s_mov_b32 s94, 0
P2_CKL:
    v_cmp_ne_u32 vcc, s92, v241
    s_add_u32 s94, s94, 1
    s_cmp_ge_u32 s94, 0x40000
    s_cbranch_scc1 P2_CKD
    s_cbranch_vccz P2_CKD
    v_lshlrev_b32 v5, 3, v0
    s_mov_b32 s3, 6455296
    buffer_load_dwordx2 v[240:241], v5, s[88:91], s3 offen sc1
    s_waitcnt vmcnt(0)
    s_branch P2_CKL
P2_CKD:
    v_max_u32_dpp v240, v240, v240 row_ror:1 row_mask:0xf bank_mask:0xf
    s_nop 1
    v_max_u32_dpp v240, v240, v240 row_ror:2 row_mask:0xf bank_mask:0xf
    s_nop 1
    v_max_u32_dpp v240, v240, v240 row_ror:4 row_mask:0xf bank_mask:0xf
    s_nop 1
    v_max_u32_dpp v240, v240, v240 row_ror:8 row_mask:0xf bank_mask:0xf
    s_nop 1
    v_readlane_b32 s52, v240, 0
    v_readlane_b32 s53, v240, 16
    v_readlane_b32 s54, v240, 32
    v_readlane_b32 s55, v240, 48
    s_mov_b32 s44, s64
    s_and_b32 s45, s65, 0xffff
    s_mov_b32 s46, 0x200000
    s_mov_b32 s47, 0x00020000
    s_max_u32 s52, s52, s53
    s_max_u32 s54, s54, s55
    s_max_u32 s52, s52, s54
    s_mov_b32 s93, s52
    s_cmp_lt_u32 s2, 224
    s_cselect_b32 s32, s32, 0xc0
    s_cmp_ge_u32 s2, 224
    s_cbranch_scc1 P2_PAD0
    s_and_b32 s52, s52, 0xffff
    s_sub_u32 s52, 0xffff, s52
    s_and_b32 s52, s52, 2047
    s_lshl_b32 s52, s52, 10
    s_and_b32 s53, s2, 7
    s_lshl_b32 s53, s53, 7
    s_add_u32 s52, s52, s53
    v_lshrrev_b32 v5, 4, v0
    v_lshlrev_b32 v5, 4, v5
    buffer_load_dwordx4 v[216:219], v5, s[44:47], s52 offen offset:0
    buffer_load_dwordx4 v[220:223], v5, s[44:47], s52 offen offset:64
    s_cmp_ge_u32 s2, 224
    s_cbranch_scc1 P2_PAD0
    s_cmp_lt_u32 s19, 2
    s_cselect_b32 s44, s74, s76
    s_cselect_b32 s45, s75, s77
    s_and_b32 s52, s2, 7
    s_mul_i32 s52, s52, 229376
    s_lshr_b32 s53, s2, 3
    s_lshl_b32 s53, s53, 7
    s_add_u32 s52, s52, s53
    s_and_b32 s45, s45, 0xffff
    s_mov_b32 s46, 0x1c0000
    s_mov_b32 s47, 0x00020000
    v_lshrrev_b32 v5, 2, v0
    v_mul_u32_u24 v5, 3584, v5
    v_and_b32 v252, 3, v0
    v_lshl_add_u32 v5, v252, 4, v5
    s_and_b32 s53, s19, 1
    s_lshl_b32 s53, s53, 6
    s_add_u32 s52, s52, s53
    s_lshl_b32 s54, s19, 12
    s_add_u32 m0, s54, 34816
    s_add_u32 s53, s52, 114688
    buffer_load_dwordx4 v5, s[44:47], s53 offen lds
    s_add_u32 m0, s54, 35840
    s_add_u32 s53, s52, 172032
    buffer_load_dwordx4 v5, s[44:47], s53 offen lds
    s_branch P2_PAD0
P2_J3:
    v_lshrrev_b32 v5, 4, v0
    v_lshlrev_b32 v5, 9, v5
    v_bfe_u32 v252, v0, 2, 2
    v_lshl_add_u32 v5, v252, 6, v5
    v_and_b32 v252, 3, v0
    v_lshl_add_u32 v5, v252, 3, v5
    s_lshl_b32 s52, s19, 12
    s_add_u32 s52, s52, 32768
    v_add_u32 v5, s52, v5
    ds_read_b64_tr_b16 v[232:233], v5 offset:0
    ds_read_b64_tr_b16 v[234:235], v5 offset:256
    ds_read_b64_tr_b16 v[236:237], v5 offset:2048
    ds_read_b64_tr_b16 v[238:239], v5 offset:2304
    s_waitcnt lgkmcnt(0)
    v_mfma_f32_16x16x32_bf16 v[240:243], v[216:219], v[232:235], 0
    v_mfma_f32_16x16x32_bf16 v[240:243], v[220:223], v[236:239], v[240:243]
    ds_read_b64_tr_b16 v[232:233], v5 offset:32
    ds_read_b64_tr_b16 v[234:235], v5 offset:288
    ds_read_b64_tr_b16 v[236:237], v5 offset:2080
    ds_read_b64_tr_b16 v[238:239], v5 offset:2336
    s_waitcnt lgkmcnt(0)
    v_mfma_f32_16x16x32_bf16 v[244:247], v[216:219], v[232:235], 0
    v_mfma_f32_16x16x32_bf16 v[244:247], v[220:223], v[236:239], v[244:247]
    v_lshlrev_b32 v5, 3, v0
    s_lshl_b32 s52, s2, 10
    s_lshl_b32 s53, s19, 8
    s_add_u32 s52, s52, s53
    s_add_u32 s52, s52, 6463488
    s_nop 3
    v_mov_b32 v241, s92
    s_mov_b32 exec_hi, 0
    s_mov_b32 exec_lo, 0xffff0000
    v_mov_b32 v240, v244
    s_mov_b32 exec_lo, -1
    buffer_store_dwordx2 v[240:241], v5, s[88:91], s52 offen sc1
    s_mov_b64 exec, -1
    s_mov_b32 s48, s78
    s_and_b32 s49, s79, 0xffff
    s_mov_b32 s50, 0x1c0000
    s_mov_b32 s51, 0x00020000
    s_lshl_b32 s52, s2, 13
    s_lshl_b32 s53, s19, 8
    s_add_u32 s52, s52, s53
    v_lshlrev_b32 v5, 2, v0
    s_add_u32 s53, s52, 4096
    buffer_load_dword v224, v5, s[48:51], s52 offen offset:0
    buffer_load_dword v225, v5, s[48:51], s52 offen offset:1024
    buffer_load_dword v226, v5, s[48:51], s52 offen offset:2048
    buffer_load_dword v227, v5, s[48:51], s52 offen offset:3072
    buffer_load_dword v228, v5, s[48:51], s53 offen offset:0
    buffer_load_dword v229, v5, s[48:51], s53 offen offset:1024
    buffer_load_dword v230, v5, s[48:51], s53 offen offset:2048
    buffer_load_dword v231, v5, s[48:51], s53 offen offset:3072
    s_branch P2_PAD0
P2_J4:
    v_lshrrev_b32 v5, 3, v0
    v_lshlrev_b32 v5, 10, v5
    v_and_b32 v252, 7, v0
    v_lshl_add_u32 v5, v252, 3, v5
    s_lshr_b32 s3, s2, 3
    s_lshl_b32 s3, s3, 13
    s_and_b32 s54, s2, 7
    s_lshl_b32 s54, s54, 6
    s_add_u32 s3, s3, s54
    s_add_u32 s3, s3, 6463488
    buffer_load_dwordx2 v[216:217], v5, s[88:91], s3 offen sc1
    buffer_load_dwordx2 v[218:219], v5, s[88:91], s3 offen offset:512 sc1
    s_branch P2_PAD0
P2_J5:
    s_mov_b32 s94, 0
P2_CPL:
    v_cmp_ne_u32 vcc, s92, v217
    v_cmp_ne_u32 s[52:53], s92, v219
    s_nop 1
    s_or_b64 vcc, vcc, s[52:53]
    s_add_u32 s94, s94, 1
    s_cmp_ge_u32 s94, 0x40000
    s_cbranch_scc1 P2_CPD
    s_cbranch_vccz P2_CPD
    v_lshrrev_b32 v5, 3, v0
    v_lshlrev_b32 v5, 10, v5
    v_and_b32 v252, 7, v0
    v_lshl_add_u32 v5, v252, 3, v5
    s_lshr_b32 s3, s2, 3
    s_lshl_b32 s3, s3, 13
    s_and_b32 s54, s2, 7
    s_lshl_b32 s54, s54, 6
    s_add_u32 s3, s3, s54
    s_add_u32 s3, s3, 6463488
    buffer_load_dwordx2 v[216:217], v5, s[88:91], s3 offen sc1
    buffer_load_dwordx2 v[218:219], v5, s[88:91], s3 offen offset:512 sc1
    s_waitcnt vmcnt(0)
    s_branch P2_CPL
P2_CPD:
    v_add_f32_dpp v216, v216, v216 row_ror:8 row_mask:0xf bank_mask:0xf
    v_add_f32_dpp v218, v218, v218 row_ror:8 row_mask:0xf bank_mask:0xf
    v_mov_b32 v217, v216
    v_mov_b32 v219, v218
    s_nop 0
    v_permlane16_swap_b32 v216, v217
    v_permlane16_swap_b32 v218, v219
    v_add_f32 v216, v216, v217
    v_add_f32 v218, v218, v219
    v_mov_b32 v217, v216
    v_mov_b32 v219, v218
    s_nop 0
    v_permlane32_swap_b32 v216, v217
    v_permlane32_swap_b32 v218, v219
    v_add_f32 v216, v216, v217
    v_add_f32 v218, v218, v219
    v_cvt_pk_bf16_f32 v216, v216, v216
    v_lshlrev_b32 v216, 16, v216
    v_cvt_pk_bf16_f32 v218, v218, v218
    v_lshlrev_b32 v218, 16, v218
    v_mul_f32 v217, 0xbfb8aa3b, v216
    v_exp_f32 v217, v217
    v_mov_b32 v220, 0
    v_add_f32 v217, 1.0, v217
    v_rcp_f32 v217, v217
    v_mov_b32 v221, 0
    v_mul_f32 v217, v217, v216
    v_cvt_pk_bf16_f32 v217, v217, v217
    v_lshlrev_b32 v217, 16, v217
    v_mul_f32 v217, v217, v218
    v_cvt_pk_bf16_f32 v217, v217, v220
    v_lshlrev_b32 v5, 2, v0
    v_readlane_b32 s44, v217, 0
    v_readlane_b32 s45, v217, 1
    v_readlane_b32 s46, v217, 2
    v_readlane_b32 s47, v217, 3
    v_readlane_b32 s48, v217, 4
    v_readlane_b32 s49, v217, 5
    v_readlane_b32 s50, v217, 6
    v_readlane_b32 s51, v217, 7
    s_lshl_b32 s60, s19, 9
    s_and_b32 s61, s2, 15
    s_lshl_b32 s61, s61, 11
    s_add_u32 s60, s60, s61
    s_add_u32 s60, s60, 6743040
    s_lshl_b32 s52, s44, 16
    s_lshl_b32 s53, s45, 16
    s_lshl_b32 s54, s46, 16
    s_lshl_b32 s55, s47, 16
    s_lshl_b32 s56, s48, 16
    s_lshl_b32 s57, s49, 16
    s_lshl_b32 s58, s50, 16
    s_lshl_b32 s59, s51, 16
    v_dot2_f32_bf16 v220, v224, s44, v220
    v_dot2_f32_bf16 v221, v224, s52, v221
    v_dot2_f32_bf16 v220, v225, s45, v220
    v_dot2_f32_bf16 v221, v225, s53, v221
    v_dot2_f32_bf16 v220, v226, s46, v220
    v_dot2_f32_bf16 v221, v226, s54, v221
    v_dot2_f32_bf16 v220, v227, s47, v220
    v_dot2_f32_bf16 v221, v227, s55, v221
    v_dot2_f32_bf16 v220, v228, s48, v220
    v_dot2_f32_bf16 v221, v228, s56, v221
    v_dot2_f32_bf16 v220, v229, s49, v220
    v_dot2_f32_bf16 v221, v229, s57, v221
    v_dot2_f32_bf16 v220, v230, s50, v220
    v_dot2_f32_bf16 v221, v230, s58, v221
    v_dot2_f32_bf16 v220, v231, s51, v220
    v_dot2_f32_bf16 v221, v231, s59, v221
    s_nop 3
    buffer_atomic_add_f32 v220, v5, s[88:91], s60 offen
    buffer_atomic_add_f32 v221, v5, s[88:91], s60 offen offset:256
    s_branch P2_PAD0
P2_J6:
    s_lshl_b32 s3, s2, 7
    s_add_u32 s3, s3, 6422528
    s_waitcnt vmcnt(0)
    v_mov_b32 v5, 1
    s_mov_b64 exec, 1
    ds_add_rtn_u32 v5, v254, v5 offset:12
    s_waitcnt lgkmcnt(0)
    v_readfirstlane_b32 s97, v5
    v_mov_b32 v5, s92
    s_nop 1
    s_cmp_lg_u32 s97, 3
    s_cbranch_scc1 P2_FL3
    buffer_store_dword v5, off, s[88:91], s3 sc1
P2_FL3:
    s_mov_b64 exec, -1
    s_mov_b32 s44, s64
    s_and_b32 s45, s65, 0xffff
    s_mov_b32 s46, 0x200000
    s_mov_b32 s47, 0x00020000
    buffer_load_dwordx4 v[176:179], v172, s[44:47], s6 offen
    buffer_load_dwordx4 v[180:183], v172, s[44:47], s6 offen offset:16
    v_lshlrev_b32 v252, 3, v6
    buffer_load_dwordx2 v[184:185], v252, s[88:91], s7 offen sc1
    s_branch P2_PAD0
P2_J7:
    s_and_b32 s52, s93, 0xffff
    s_sub_u32 s52, 0xffff, s52
    s_lshr_b32 s52, s52, 5
    s_cmp_lg_u32 s52, s4
    s_cbranch_scc1 P2_PAD0
    v_lshlrev_b32 v252, 7, v0
    s_mov_b32 s3, 6422528
    buffer_load_dword v186, v252, s[88:91], s3 offen sc1
    s_mov_b32 s3, 6430720
    buffer_load_dword v187, v252, s[88:91], s3 offen sc1
    s_mov_b32 s3, 6438912
    buffer_load_dword v188, v252, s[88:91], s3 offen sc1
    s_mov_b32 s3, 6447104
    buffer_load_dword v189, v252, s[88:91], s3 offen sc1
    s_branch P2_PAD0
P2_EXACT:
    s_mov_b32 s29, 1
    s_mov_b32 s32, 0
    s_mov_b32 s23, 0xff800000
    v_mov_b32 v216, s23
    v_mov_b32 v217, s23
    s_mov_b32 s28, s22
    s_mov_b32 s23, 0
    s_waitcnt vmcnt(0) lgkmcnt(0)
P2_EXLOOP:
    buffer_load_dwordx4 v[120:123], v2, s[88:91], s28 offen sc1
    s_waitcnt vmcnt(0)
    v_mfma_f32_32x32x16_bf16 v[80:95], v[120:123], v[8:11], 0
    s_nop 15
    v_max3_f32 v216, v216, v80, v81
    v_max3_f32 v216, v216, v82, v83
    v_max3_f32 v216, v216, v84, v85
    v_max3_f32 v216, v216, v86, v87
    v_max3_f32 v216, v216, v88, v89
    v_max3_f32 v216, v216, v90, v91
    v_max3_f32 v216, v216, v92, v93
    v_max3_f32 v216, v216, v94, v95
    v_mfma_f32_32x32x16_bf16 v[80:95], v[120:123], v[12:15], 0
    s_nop 15
    v_max3_f32 v217, v217, v80, v81
    v_max3_f32 v217, v217, v82, v83
    v_max3_f32 v217, v217, v84, v85
    v_max3_f32 v217, v217, v86, v87
    v_max3_f32 v217, v217, v88, v89
    v_max3_f32 v217, v217, v90, v91
    v_max3_f32 v217, v217, v92, v93
    v_max3_f32 v217, v217, v94, v95
    s_add_u32 s28, s28, 2048
    s_add_u32 s23, s23, 1
    s_cmp_lt_u32 s23, 32
    s_cbranch_scc1 P2_EXLOOP
    s_lshl_b32 s23, s19, 9
    s_lshl_b32 s28, s16, 8
    s_add_u32 s23, s23, 0
    v_lshl_add_u32 v5, v0, 2, s23
    v_add_u32 v252, s28, v5
    v_xor_b32 v253, 256, v252
    ds_write_b32 v253, v216
    ds_write_b32 v252, v217
    s_waitcnt lgkmcnt(0)
    s_barrier
    s_lshl_b32 s23, s17, 9
    s_add_u32 s23, s23, 0
    v_lshl_add_u32 v5, v6, 2, s23
    v_add_u32 v252, s28, v5
    v_xor_b32 v253, 256, v252
    ds_read_b32 v80, v253 offset:0
    ds_read_b32 v81, v253 offset:128
    ds_read_b32 v82, v253 offset:2048
    ds_read_b32 v83, v253 offset:2176
    s_waitcnt lgkmcnt(0)
    v_max3_f32 v80, v80, v81, v82
    v_max_f32 v80, v80, v83
    v_sub_f32 v16, 0, v80
    ds_read_b32 v80, v252 offset:0
    ds_read_b32 v81, v252 offset:128
    ds_read_b32 v82, v252 offset:2048
    ds_read_b32 v83, v252 offset:2176
    s_waitcnt lgkmcnt(0)
    v_max3_f32 v80, v80, v81, v82
    v_max_f32 v80, v80, v83
    v_sub_f32 v32, 0, v80
    v_mov_b64 v[124:125], 0
    v_mov_b64 v[126:127], 0
    v_mov_b64 v[128:129], 0
    v_mov_b64 v[130:131], 0
    v_mov_b64 v[136:137], 0
    v_mov_b64 v[138:139], 0
    v_mov_b64 v[140:141], 0
    v_mov_b64 v[142:143], 0
    v_mov_b64 v[148:149], 0
    v_mov_b64 v[150:151], 0
    v_mov_b64 v[152:153], 0
    v_mov_b64 v[154:155], 0
    v_mov_b64 v[160:161], 0
    v_mov_b64 v[162:163], 0
    v_mov_b64 v[164:165], 0
    v_mov_b64 v[166:167], 0
    s_mov_b32 s34, 0x3f803f80
    s_mov_b32 s35, 0x3f803f80
    s_mov_b32 exec_lo, 0x00110000
    s_mov_b32 exec_hi, 0x00110000
    v_mov_b64 v[124:125], s[34:35]
    v_mov_b64 v[126:127], s[34:35]
    v_mov_b64 v[128:129], s[34:35]
    v_mov_b64 v[130:131], s[34:35]
    v_mov_b64 v[136:137], s[34:35]
    v_mov_b64 v[138:139], s[34:35]
    v_mov_b64 v[140:141], s[34:35]
    v_mov_b64 v[142:143], s[34:35]
    v_mov_b64 v[148:149], s[34:35]
    v_mov_b64 v[150:151], s[34:35]
    v_mov_b64 v[152:153], s[34:35]
    v_mov_b64 v[154:155], s[34:35]
    v_mov_b64 v[160:161], s[34:35]
    v_mov_b64 v[162:163], s[34:35]
    v_mov_b64 v[164:165], s[34:35]
    v_mov_b64 v[166:167], s[34:35]
    s_mov_b64 exec, -1
    v_mov_b64 v[48:49], 0
    v_mov_b64 v[50:51], 0
    v_mov_b64 v[52:53], 0
    v_mov_b64 v[54:55], 0
    v_mov_b64 v[56:57], 0
    v_mov_b64 v[58:59], 0
    v_mov_b64 v[60:61], 0
    v_mov_b64 v[62:63], 0
    v_mov_b64 v[64:65], 0
    v_mov_b64 v[66:67], 0
    v_mov_b64 v[68:69], 0
    v_mov_b64 v[70:71], 0
    v_mov_b64 v[72:73], 0
    v_mov_b64 v[74:75], 0
    v_mov_b64 v[76:77], 0
    v_mov_b64 v[78:79], 0
    v_mov_b32 v202, 0xdddd
    v_mov_b64 v[104:105], 0
    v_mov_b64 v[106:107], 0
    v_mov_b64 v[108:109], 0
    v_mov_b64 v[110:111], 0
    s_lshl_b32 s28, s14, 11
    s_mov_b32 s21, s28
    buffer_load_dwordx4 v[120:123], v196, s[88:91], s28 offen sc1
    s_mov_b64 exec, s[30:31]
    buffer_load_dwordx4 v[124:127], v197, s[88:91], s28 offen offset:1024 sc1
    buffer_load_dwordx4 v[128:131], v197, s[88:91], s28 offen offset:1536 sc1
    s_mov_b64 exec, -1
    s_add_u32 s28, s28, 2048
    s_and_b32 s28, s28, 0xffff
    s_waitcnt vmcnt(0)
    s_branch P2_START
L_CODE_END:
.section .rodata,"a"
.p2align 6
.amdhsa_kernel gated_mix__mha_block__moe_arch_mod__prompt_kernel
  .amdhsa_next_free_vgpr 256
  .amdhsa_next_free_sgpr 102
  .amdhsa_accum_offset 256
  .amdhsa_group_segment_fixed_size 0
  .amdhsa_kernarg_size 96
  .amdhsa_user_sgpr_count 2
  .amdhsa_user_sgpr_kernarg_segment_ptr 1
  .amdhsa_system_sgpr_workgroup_id_x 1
.end_amdhsa_kernel
```
